```python
import torch

def _softmax(x, axis=-1):
    return torch.softmax(x, dim=axis)
def _gelu(x):
    return torch.nn.functional.gelu(x, approximate="tanh")
def _silu(x):
    return torch.nn.functional.silu(x)
def _sigmoid(x):
    return torch.sigmoid(x)
def _layernorm(x, axis=-1, eps=1e-5):
    m = x.mean(dim=axis, keepdim=True)
    v = x.var(dim=axis, keepdim=True, unbiased=False)
    return (x - m) / torch.sqrt(v + eps)
def _scatter_add(tgt, idx, src, axis=0):
    return tgt.clone().index_add_(axis, idx, src)
def _segment_sum(src, seg, n):
    out = torch.zeros((n,) + src.shape[1:], dtype=src.dtype)
    return out.index_add_(0, seg, src)
def _pad(x, pw):
    flat = tuple(v for pair in reversed(pw) for v in pair)
    return torch.nn.functional.pad(x, flat)

kernel_name = 'gated_mix__ssm_conv_h3__grouped_kv_mqa__prompt'

def setup_inputs():

    _w = (lambda a: (lambda t: t.to(torch.bfloat16) if t.is_floating_point() else t)(torch.as_tensor(a)))
    def _A_setup():
        B, S, D = 1, 2048, 640
        ks = 4
        return {
            "q": _w((lambda *s: torch.randn(*s, dtype=torch.bfloat16) * 0.05)(B, S, D)),
            "k": _w((lambda *s: torch.randn(*s, dtype=torch.bfloat16) * 0.2)(B, S, D)),
            "v": _w((lambda *s: torch.randn(*s, dtype=torch.bfloat16) * 0.2)(B, S, D)),
            "shift_k": _w((lambda *s: torch.randn(*s, dtype=torch.bfloat16) * 0.2)(D, ks) * 0.5),
            "ssm_k": _w((lambda *s: torch.randn(*s, dtype=torch.bfloat16) * 0.8)(D, S) * (1.0 / S ** 0.5)),
            "ssm_D": _w((lambda *s: torch.randn(*s, dtype=torch.bfloat16) * 0.2)(D)),
        }
    _A_in = _A_setup()

    def _B_setup():
        B, S, D, H = 1, 2048, 640, 32
        Dh = D // H
        return {
            "x": _w((lambda *s: torch.randn(*s, dtype=torch.bfloat16) * 0.05)(B, S, D)),
            "wq": _w((lambda *s: torch.randn(*s, dtype=torch.bfloat16) * 0.8)(D, H * Dh)),
            "wk": _w((lambda *s: torch.randn(*s, dtype=torch.bfloat16) * 0.8)(D, Dh)),
            "wv": _w((lambda *s: torch.randn(*s, dtype=torch.bfloat16) * 0.05)(D, Dh)),
            "wo": _w((lambda *s: torch.randn(*s, dtype=torch.bfloat16) * 0.05)(H * Dh, D)),
        }
    _B_in = _B_setup()

    return {
        "A_q": _A_in["q"],
        "A_k": _A_in["k"],
        "A_v": _A_in["v"],
        "A_shift_k": _A_in["shift_k"],
        "A_ssm_k": _A_in["ssm_k"],
        "A_ssm_D": _A_in["ssm_D"],
        "B_x": _B_in["x"],
        "B_wq": _B_in["wq"],
        "B_wk": _B_in["wk"],
        "B_wv": _B_in["wv"],
        "B_wo": _B_in["wo"],
        "gate_w": _w((lambda *s: torch.randn(*s, dtype=torch.bfloat16) * 0.05)(640) * 16.0),
    }

def reference(A_q, A_k, A_v, A_shift_k, A_ssm_k, A_ssm_D, B_x, B_wq, B_wk, B_wv, B_wo, gate_w):
    def _A_ref(q, k, v, shift_k, ssm_k, ssm_D):
        B, S, D = q.shape
        ks = shift_k.shape[-1]
        k_pad = _pad(k, ((0, 0), (ks - 1, 0), (0, 0)))
        k_shift = torch.zeros_like(k)
        for t in range(ks):
            k_shift = k_shift + k_pad[:, t:t + S, :] * shift_k[:, ks - 1 - t][None, None, :]
        kv = k_shift * v
        L = 2 * S
        kv_pad = _pad(kv, ((0, 0), (0, S), (0, 0)))
        kf_pad = _pad(ssm_k, ((0, 0), (0, S)))
        kv_f = (lambda x, axes=(-2,-1): torch.fft.rfft2(x.float(), dim=axes))(kv_pad[:, None, :, :], axes=(1, 2))
        kf_f = (lambda x, axes=(-2,-1): torch.fft.rfft2(x.float(), dim=axes))(kf_pad[:, None, :], axes=(1, 2))
        kf_f = (lambda x, *d: x.permute(*d))(kf_f, 1, 2, 0)
        y_f = kv_f * kf_f[None, :, :, :]
        y = (lambda x, s, axes=(-2,-1): torch.fft.irfft2(x, s=s, dim=axes).to(torch.bfloat16))(y_f, (1, L), axes=(1, 2))[:, 0, :S, :]
        y = y + kv * ssm_D[None, None, :]
        return q * y

    def _B_ref(x, wq, wk, wv, wo):
        B, S, D = x.shape
        H = 32
        Dh = D // H
        q = (lambda x, *d: x.permute(*d))((x @ wq).reshape(B, S, H, Dh), 0, 2, 1, 3)
        k = x @ wk
        v = x @ wv
        scores = torch.einsum("bhqd,bkd->bhqk", q, k) * (Dh ** -0.5)
        p = _softmax(scores, axis=-1)
        o = torch.einsum("bhqk,bkd->bhqd", p, v)
        return (lambda x, *d: x.permute(*d))(o, 0, 2, 1, 3).reshape(B, S, H * Dh) @ wo

    x = A_q
    g = _sigmoid((x * gate_w).sum(-1, keepdims=True))
    a = _A_ref(x, A_k, A_v, A_shift_k, A_ssm_k, A_ssm_D)
    b = _B_ref(x, B_wq, B_wk, B_wv, B_wo)
    return g * a + (1 - g) * b
```

```asm
; @launch grid=(256,1,1) block=(768,1,1) lds=163840
.amdgcn_target "amdgcn-amd-amdhsa--gfx950"
.text
.globl gated_mix__ssm_conv_h3__grouped_kv_mqa__prompt_kernel
.p2align 8
.type gated_mix__ssm_conv_h3__grouped_kv_mqa__prompt_kernel,@function
gated_mix__ssm_conv_h3__grouped_kv_mqa__prompt_kernel:

    s_cmp_ge_u32 s2, 256
    s_cbranch_scc1 f_end
    s_load_dwordx16 s[76:91], s[0:1], 0
    s_load_dwordx8 s[92:99], s[0:1], 64
    s_load_dwordx4 s[28:31], s[0:1], 96
    s_load_dwordx2 s[32:33], s[0:1], 112
    v_lshrrev_b32 v1, 6, v0
    s_and_b32 s20, s2, 7
    s_lshl_b32 s20, s20, 2
    s_lshr_b32 s21, s2, 6
    s_add_u32 s20, s20, s21
    s_lshr_b32 s21, s2, 3
    s_and_b32 s21, s21, 7
    v_readfirstlane_b32 s22, v1
    v_and_b32 v1, 63, v0
    s_movk_i32 s26, 1280
    s_add_u32 s27, s20, s21
    s_and_b32 s27, s27, 7
    s_and_b32 s23, s22, 3
    s_lshr_b32 s24, s22, 2
    s_mov_b32 s6, 2621440
    s_mov_b32 s7, 0x00020000
    s_mov_b32 s58, 25600
    s_mov_b32 s59, 0x00020000
    s_and_b32 s34, s21, 3
    s_lshl_b32 s34, s34, 4
    s_lshl_b32 s35, s20, 6
    s_add_u32 s34, s34, s35
    v_and_b32 v2, 15, v1
    v_add_u32 v2, s34, v2
    v_mul_lo_u32 v2, v2, s26
    v_lshrrev_b32 v3, 4, v1
    v_lshlrev_b32 v164, 4, v3
    v_add_u32 v2, v2, v164
    v_lshlrev_b32 v164, 4, v1
    s_mul_i32 s35, s22, 320
    s_mul_i32 s36, s22, 6400
    s_mul_i32 s37, s22, 6656
    s_cmp_ge_u32 s21, 4
    s_waitcnt lgkmcnt(0)
    s_cselect_b32 s56, s94, s92
    s_cselect_b32 s57, s95, s93
    s_mov_b32 s4, s76
    s_mov_b32 s5, s77
    s_mov_b32 s38, s31
    s_cmp_ge_u32 s22, 4
    s_cbranch_scc1 ifw_1
    s_setprio 2
    buffer_load_dwordx4 v[16:19], v2, s[4:7], s35 offen offset:0
    buffer_load_dwordx4 v[20:23], v2, s[4:7], s35 offen offset:64
    buffer_load_dwordx4 v[24:27], v2, s[4:7], s35 offen offset:128
    buffer_load_dwordx4 v[28:31], v2, s[4:7], s35 offen offset:192
    buffer_load_dwordx4 v[32:35], v2, s[4:7], s35 offen offset:256
    s_add_u32 m0, s37, 131552
    s_add_u32 s31, s36, 0
    buffer_load_dwordx4 v164, s[56:59], s31 offen lds
    s_add_u32 m0, s37, 132576
    s_add_u32 s31, s36, 1024
    buffer_load_dwordx4 v164, s[56:59], s31 offen lds
    s_add_u32 m0, s37, 133600
    s_add_u32 s31, s36, 2048
    buffer_load_dwordx4 v164, s[56:59], s31 offen lds
    s_add_u32 m0, s37, 134624
    s_add_u32 s31, s36, 3072
    buffer_load_dwordx4 v164, s[56:59], s31 offen lds
    s_add_u32 m0, s37, 135648
    s_add_u32 s31, s36, 4096
    buffer_load_dwordx4 v164, s[56:59], s31 offen lds
    s_add_u32 m0, s37, 136672
    s_add_u32 s31, s36, 5120
    buffer_load_dwordx4 v164, s[56:59], s31 offen lds
    s_add_u32 m0, s37, 137696
    s_add_u32 s31, s36, 6144
    s_mov_b64 exec, 0xffffffff
    buffer_load_dwordx4 v164, s[56:59], s31 offen lds
    s_mov_b64 exec, -1
    s_setprio 0
ifw_1:
    s_mov_b32 s31, s38
    s_mov_b32 s8, s90
    s_mov_b32 s9, s91
    s_mov_b32 s10, 819200
    s_mov_b32 s11, 0x00020000
    s_mov_b32 s60, s98
    s_mov_b32 s61, s99
    s_mov_b32 s62, 1280
    s_mov_b32 s63, 0x00020000
    s_mov_b32 s44, s78
    s_mov_b32 s45, s79
    s_mov_b32 s46, 2621440
    s_mov_b32 s47, 0x00020000
    s_mov_b32 s48, s80
    s_mov_b32 s49, s81
    s_mov_b32 s50, 2621440
    s_mov_b32 s51, 0x00020000
    s_mov_b32 s52, s82
    s_mov_b32 s53, s83
    s_mov_b32 s54, 5120
    s_mov_b32 s55, 0x00020000
    s_mov_b32 s12, s32
    s_mov_b32 s13, s33
    s_mov_b32 s14, 9437184
    s_mov_b32 s15, 0x00020000
    s_mov_b32 s72, s30
    s_mov_b32 s73, s31
    s_mov_b32 s74, 256
    s_mov_b32 s75, 0x00020000
    s_mov_b32 s16, s84
    s_mov_b32 s17, s85
    s_mov_b32 s18, 2621440
    s_mov_b32 s19, 0x00020000
    s_mov_b32 s64, s96
    s_mov_b32 s65, s97
    s_mov_b32 s66, 819200
    s_mov_b32 s67, 0x00020000
    s_mov_b32 s68, s28
    s_mov_b32 s69, s29
    s_mov_b32 s70, 2621440
    s_mov_b32 s71, 0x00020000
    s_mov_b32 s76, s86
    s_mov_b32 s77, s87
    s_mul_i32 s37, s20, 3
    s_lshl_b32 s34, s20, 1
    s_add_u32 s34, s34, 16
    s_cmp_lt_u32 s20, 16
    s_cselect_b32 s35, s37, s34
    s_cselect_b32 s84, 3, 2
    s_mul_i32 s34, s21, 80
    s_add_u32 s35, s35, s34
    s_sub_u32 s38, s22, 9
    s_add_u32 s83, s35, s38
    s_mul_i32 s85, s38, 21248
    s_add_u32 s85, s85, 49152
    s_add_u32 s97, s20, s21
    s_mul_i32 s96, s97, 52
    s_lshr_b32 s96, s96, 8
    s_mul_i32 s96, s96, 5
    s_sub_u32 s97, s97, s96
    s_cmp_eq_u32 s22, 8
    s_cbranch_scc1 f_pstart
    s_cmp_gt_u32 s22, 8
    s_cbranch_scc1 f_lstart
    v_lshrrev_b32 v2, 4, v1
    s_lshl_b32 s28, s22, 2
    v_add_u32 v2, s28, v2
    v_xor_b32 v3, v1, v2
    v_and_b32 v3, 15, v3
    v_lshlrev_b32 v3, 4, v3
    s_lshl_b32 s28, s20, 6
    v_add_u32 v2, s28, v2
    v_mul_lo_u32 v2, v2, s26
    v_add_u32 v112, v2, v3
    s_mul_i32 s29, s21, 160
    s_lshl_b32 s28, s22, 6
    v_add_u32 v2, s28, v1
    v_mul_u32_u24 v3, 6554, v2
    v_lshrrev_b32 v3, 16, v3
    v_mul_u32_u24 v164, 10, v3
    v_sub_u32 v2, v2, v164
    v_lshlrev_b32 v2, 4, v2
    v_and_b32 v164, 0xfff8, v3
    v_bfe_u32 v165, v3, 1, 2
    v_or_b32 v164, v164, v165
    v_and_b32 v3, 1, v3
    v_lshlrev_b32 v3, 2, v3
    v_or_b32 v164, v164, v3
    v_mul_lo_u32 v164, v164, s26
    v_add_u32 v164, v164, v2
    v_add_u32 v113, s29, v164
    v_add_u32 v2, s28, v1
    v_add_u32 v2, 512, v2
    v_mul_u32_u24 v3, 6554, v2
    v_lshrrev_b32 v3, 16, v3
    v_mul_u32_u24 v164, 10, v3
    v_sub_u32 v2, v2, v164
    v_lshlrev_b32 v2, 4, v2
    v_and_b32 v164, 0xfff8, v3
    v_bfe_u32 v165, v3, 1, 2
    v_or_b32 v164, v164, v165
    v_and_b32 v3, 1, v3
    v_lshlrev_b32 v3, 2, v3
    v_or_b32 v164, v164, v3
    v_mul_lo_u32 v164, v164, s26
    v_add_u32 v164, v164, v2
    v_add_u32 v114, s29, v164
    v_add_u32 v2, s28, v1
    v_add_u32 v2, 1024, v2
    v_mul_u32_u24 v3, 6554, v2
    v_lshrrev_b32 v3, 16, v3
    v_mul_u32_u24 v164, 10, v3
    v_sub_u32 v2, v2, v164
    v_lshlrev_b32 v2, 4, v2
    v_and_b32 v164, 0xfff8, v3
    v_bfe_u32 v165, v3, 1, 2
    v_or_b32 v164, v164, v165
    v_and_b32 v3, 1, v3
    v_lshlrev_b32 v3, 2, v3
    v_or_b32 v164, v164, v3
    v_mul_lo_u32 v164, v164, s26
    v_add_u32 v164, v164, v2
    v_add_u32 v115, s29, v164
    s_cmp_lt_u32 s22, 4
    s_cbranch_scc1 ifw_2
    s_mul_i32 s28, s23, 320
    s_add_u32 m0, s28, 159744
    v_lshlrev_b32 v2, 4, v1
    s_mov_b64 exec, 0xfffff
    buffer_load_dwordx4 v2, s[60:63], s28 offen lds
    s_mov_b64 exec, -1
ifw_2:
    s_add_u32 s94, s97, 0
    s_sub_u32 s92, s94, 5
    s_cmp_ge_u32 s94, 5
    s_cselect_b32 s94, s92, s94
    s_lshl_b32 s92, s94, 8
    s_mul_i32 s93, s94, 163840
    s_lshl_b32 s28, s22, 10
    s_add_u32 m0, s28, 0
    s_add_u32 s29, s92, 0
    buffer_load_dwordx4 v112, s[4:7], s29 offen lds
    s_add_u32 m0, s28, 8192
    s_add_u32 s29, s92, 40960
    buffer_load_dwordx4 v112, s[4:7], s29 offen lds
    s_mov_b32 s29, s93
    s_add_u32 m0, s28, 16384
    s_nop 0
    buffer_load_dwordx4 v113, s[8:11], s29 offen lds
    s_add_u32 m0, s28, 24576
    s_nop 0
    buffer_load_dwordx4 v114, s[8:11], s29 offen lds
    s_cmp_ge_u32 s22, 4
    s_cbranch_scc1 ifw_3
    s_add_u32 m0, s28, 32768
    s_nop 0
    buffer_load_dwordx4 v115, s[8:11], s29 offen lds
ifw_3:
    s_add_u32 s94, s97, 1
    s_sub_u32 s92, s94, 5
    s_cmp_ge_u32 s94, 5
    s_cselect_b32 s94, s92, s94
    s_lshl_b32 s92, s94, 8
    s_mul_i32 s93, s94, 163840
    s_lshl_b32 s28, s22, 10
    s_add_u32 m0, s28, 36864
    s_add_u32 s29, s92, 0
    buffer_load_dwordx4 v112, s[4:7], s29 offen lds
    s_add_u32 m0, s28, 45056
    s_add_u32 s29, s92, 40960
    buffer_load_dwordx4 v112, s[4:7], s29 offen lds
    s_mov_b32 s29, s93
    s_add_u32 m0, s28, 53248
    s_nop 0
    buffer_load_dwordx4 v113, s[8:11], s29 offen lds
    s_add_u32 m0, s28, 61440
    s_nop 0
    buffer_load_dwordx4 v114, s[8:11], s29 offen lds
    s_cmp_ge_u32 s22, 4
    s_cbranch_scc1 ifw_4
    s_add_u32 m0, s28, 69632
    s_nop 0
    buffer_load_dwordx4 v115, s[8:11], s29 offen lds
ifw_4:
    s_barrier
    s_cmp_ge_u32 s22, 4
    s_cbranch_scc1 ifw_5
    v_lshrrev_b32 v3, 4, v1
    v_bfe_u32 v164, v1, 2, 2
    v_lshlrev_b32 v3, 3, v3
    v_add_u32 v164, v164, v3
    v_mul_u32_u24 v164, 40, v164
    v_and_b32 v165, 3, v1
    v_lshlrev_b32 v165, 3, v165
    v_add_u32 v164, v164, v165
    s_mul_i32 s30, s22, 6656
    s_add_u32 s30, s30, 131552
    v_add_u32 v164, s30, v164
    v_mov_b32 v4, 0
    v_mov_b32 v5, 0
    v_mov_b32 v6, 0
    v_mov_b32 v7, 0
    v_mov_b32 v8, 0
    v_mov_b32 v9, 0
    v_mov_b32 v10, 0
    v_mov_b32 v11, 0
    s_waitcnt vmcnt(10)
    ds_read_b64_tr_b16 v[44:45], v164 offset:0
    ds_read_b64_tr_b16 v[46:47], v164 offset:160
    ds_read_b64_tr_b16 v[48:49], v164 offset:32
    ds_read_b64_tr_b16 v[50:51], v164 offset:192
    ds_read_b64_tr_b16 v[52:53], v164 offset:1280
    ds_read_b64_tr_b16 v[54:55], v164 offset:1440
    ds_read_b64_tr_b16 v[56:57], v164 offset:1312
    ds_read_b64_tr_b16 v[58:59], v164 offset:1472
    ds_read_b64_tr_b16 v[60:61], v164 offset:2560
    ds_read_b64_tr_b16 v[62:63], v164 offset:2720
    ds_read_b64_tr_b16 v[64:65], v164 offset:2592
    ds_read_b64_tr_b16 v[66:67], v164 offset:2752
    s_waitcnt lgkmcnt(4)
    ds_read_b64_tr_b16 v[68:69], v164 offset:3840
    ds_read_b64_tr_b16 v[70:71], v164 offset:4000
    ds_read_b64_tr_b16 v[72:73], v164 offset:3872
    ds_read_b64_tr_b16 v[74:75], v164 offset:4032
    ds_read_b64_tr_b16 v[76:77], v164 offset:5120
    ds_read_b64_tr_b16 v[78:79], v164 offset:5280
    ds_read_b64_tr_b16 v[80:81], v164 offset:5152
    ds_read_b64_tr_b16 v[82:83], v164 offset:5312
    s_waitcnt lgkmcnt(0)
    s_cmp_ge_u32 s21, 4
    s_cbranch_scc1 kindV_6
    v_mfma_f32_16x16x32_bf16 v[4:7], v[44:47], v[16:19], v[4:7]
    v_mfma_f32_16x16x32_bf16 v[8:11], v[48:51], v[16:19], v[8:11]
    v_mfma_f32_16x16x32_bf16 v[4:7], v[52:55], v[20:23], v[4:7]
    v_mfma_f32_16x16x32_bf16 v[8:11], v[56:59], v[20:23], v[8:11]
    v_mfma_f32_16x16x32_bf16 v[4:7], v[60:63], v[24:27], v[4:7]
    v_mfma_f32_16x16x32_bf16 v[8:11], v[64:67], v[24:27], v[8:11]
    v_mfma_f32_16x16x32_bf16 v[4:7], v[68:71], v[28:31], v[4:7]
    v_mfma_f32_16x16x32_bf16 v[8:11], v[72:75], v[28:31], v[8:11]
    v_mfma_f32_16x16x32_bf16 v[4:7], v[76:79], v[32:35], v[4:7]
    v_mfma_f32_16x16x32_bf16 v[8:11], v[80:83], v[32:35], v[8:11]
    s_branch kindD_7
kindV_6:
    v_mfma_f32_16x16x32_bf16 v[4:7], v[16:19], v[44:47], v[4:7]
    v_mfma_f32_16x16x32_bf16 v[8:11], v[16:19], v[48:51], v[8:11]
    v_mfma_f32_16x16x32_bf16 v[4:7], v[20:23], v[52:55], v[4:7]
    v_mfma_f32_16x16x32_bf16 v[8:11], v[20:23], v[56:59], v[8:11]
    v_mfma_f32_16x16x32_bf16 v[4:7], v[24:27], v[60:63], v[4:7]
    v_mfma_f32_16x16x32_bf16 v[8:11], v[24:27], v[64:67], v[8:11]
    v_mfma_f32_16x16x32_bf16 v[4:7], v[28:31], v[68:71], v[4:7]
    v_mfma_f32_16x16x32_bf16 v[8:11], v[28:31], v[72:75], v[8:11]
    v_mfma_f32_16x16x32_bf16 v[4:7], v[32:35], v[76:79], v[4:7]
    v_mfma_f32_16x16x32_bf16 v[8:11], v[32:35], v[80:83], v[8:11]
kindD_7:
    s_nop 7
    s_mul_i32 s29, s22, 6656
    s_add_u32 s29, s29, 131552
    v_lshlrev_b32 v2, 4, v1
    v_add_u32 v3, s29, v2
    ds_write_b128 v3, v[4:7]
    ds_write_b128 v3, v[8:11] offset:1024
    v_mov_b32 v2, 162412
    v_mov_b32 v3, 1
    s_mov_b64 exec, 1
    ds_add_u32 v2, v3
    s_mov_b64 exec, -1
ifw_5:
    v_and_b32 v2, 31, v1
    s_lshl_b32 s28, s24, 5
    v_add_u32 v2, s28, v2
    v_lshrrev_b32 v3, 5, v1
    v_and_b32 v164, 15, v2
    v_xor_b32 v164, v164, v3
    v_lshlrev_b32 v164, 4, v164
    v_lshlrev_b32 v2, 8, v2
    v_add_u32 v24, v2, v164
    v_xor_b32 v25, 32, v24
    v_xor_b32 v26, 64, v24
    v_xor_b32 v27, 96, v24
    v_xor_b32 v28, 128, v24
    v_xor_b32 v29, 160, v24
    v_xor_b32 v30, 192, v24
    v_xor_b32 v31, 224, v24
    v_bfe_u32 v2, v1, 2, 2
    v_lshlrev_b32 v2, 1, v2
    v_lshlrev_b32 v164, 3, v3
    v_add_u32 v2, v2, v164
    v_mul_u32_u24 v2, 160, v2
    v_and_b32 v164, 3, v1
    v_lshlrev_b32 v164, 3, v164
    v_and_b32 v165, 16, v1
    v_cmp_ne_u32 vcc, 0, v165
    s_mul_i32 s28, s23, 40
    s_add_u32 s28, s28, 16384
    v_mov_b32 v165, 32
    v_cndmask_b32 v164, v164, v165, vcc
    v_add_u32 v2, v2, v164
    v_add_u32 v32, s28, v2
    v_mov_b32 v44, 0
    v_mov_b32 v60, 0
    v_mov_b32 v45, 0
    v_mov_b32 v61, 0
    v_mov_b32 v46, 0
    v_mov_b32 v62, 0
    v_mov_b32 v47, 0
    v_mov_b32 v63, 0
    v_mov_b32 v48, 0
    v_mov_b32 v64, 0
    v_mov_b32 v49, 0
    v_mov_b32 v65, 0
    v_mov_b32 v50, 0
    v_mov_b32 v66, 0
    v_mov_b32 v51, 0
    v_mov_b32 v67, 0
    v_mov_b32 v52, 0
    v_mov_b32 v68, 0
    v_mov_b32 v53, 0
    v_mov_b32 v69, 0
    v_mov_b32 v54, 0
    v_mov_b32 v70, 0
    v_mov_b32 v55, 0
    v_mov_b32 v71, 0
    v_mov_b32 v56, 0
    v_mov_b32 v72, 0
    v_mov_b32 v57, 0
    v_mov_b32 v73, 0
    v_mov_b32 v58, 0
    v_mov_b32 v74, 0
    v_mov_b32 v59, 0
    v_mov_b32 v75, 0
    v_lshlrev_b32 v3, 4, v3
    s_lshl_b32 s28, s23, 5
    s_add_u32 s28, s28, 159744
    v_add_u32 v33, s28, v3
    s_cmp_lt_u32 s22, 4
    s_cbranch_scc1 wa_8
    s_waitcnt vmcnt(4)
    s_branch wb_9
wa_8:
    s_waitcnt vmcnt(5)
wb_9:
    v_mov_b32 v2, 162432
    v_mov_b32 v3, 1
    s_mov_b64 exec, 1
    ds_add_u32 v2, v3
    s_mov_b64 exec, -1
    v_mov_b32 v2, 162432
    s_mov_b32 s43, 0
lw_10:
    ds_read_b32 v3, v2
    s_waitcnt lgkmcnt(0)
    v_readfirstlane_b32 s42, v3
    s_nop 3
    s_cmp_ge_u32 s42, 8
    s_cbranch_scc1 lwd_11
    s_add_u32 s43, s43, 1
    s_cmp_lt_u32 s43, 320000
    s_cbranch_scc0 lwd_11
    s_branch lw_10
lwd_11:
    s_add_u32 s94, s97, 0
    s_sub_u32 s92, s94, 5
    s_cmp_ge_u32 s94, 5
    s_cselect_b32 s94, s92, s94
    s_lshl_b32 s92, s94, 8
    s_mul_i32 s93, s94, 163840
    v_add_u32 v2, s92, v33
    ds_read_b128 v[76:79], v2
    ds_read_b128 v[80:83], v2 offset:128
    ds_read_b128 v[84:87], v24 offset:0
    ds_read_b64_tr_b16 v[96:97], v32 offset:0
    ds_read_b64_tr_b16 v[98:99], v32 offset:160
    ds_read_b128 v[88:91], v25 offset:0
    ds_read_b64_tr_b16 v[100:101], v32 offset:2560
    ds_read_b64_tr_b16 v[102:103], v32 offset:2720
    ds_read_b128 v[92:95], v26 offset:0
    ds_read_b64_tr_b16 v[104:105], v32 offset:5120
    ds_read_b64_tr_b16 v[106:107], v32 offset:5280
    s_waitcnt lgkmcnt(6)
    v_mfma_f32_32x32x16_bf16 v[44:59], v[96:99], v[84:87], v[44:59]
    s_cmp_lg_u32 s23, 0
    s_cbranch_scc1 ng_12
    v_mfma_f32_32x32x16_bf16 v[60:75], v[76:79], v[84:87], v[60:75]
ng_12:
    ds_read_b128 v[84:87], v27 offset:0
    ds_read_b64_tr_b16 v[96:97], v32 offset:7680
    ds_read_b64_tr_b16 v[98:99], v32 offset:7840
    s_waitcnt lgkmcnt(6)
    v_mfma_f32_32x32x16_bf16 v[44:59], v[100:103], v[88:91], v[44:59]
    s_cmp_lg_u32 s23, 1
    s_cbranch_scc1 ng_13
    v_mfma_f32_32x32x16_bf16 v[60:75], v[76:79], v[88:91], v[60:75]
ng_13:
    ds_read_b128 v[88:91], v28 offset:0
    ds_read_b64_tr_b16 v[100:101], v32 offset:10240
    ds_read_b64_tr_b16 v[102:103], v32 offset:10400
    s_waitcnt lgkmcnt(6)
    v_mfma_f32_32x32x16_bf16 v[44:59], v[104:107], v[92:95], v[44:59]
    s_cmp_lg_u32 s23, 2
    s_cbranch_scc1 ng_14
    v_mfma_f32_32x32x16_bf16 v[60:75], v[76:79], v[92:95], v[60:75]
ng_14:
    ds_read_b128 v[92:95], v29 offset:0
    ds_read_b64_tr_b16 v[104:105], v32 offset:12800
    ds_read_b64_tr_b16 v[106:107], v32 offset:12960
    s_waitcnt lgkmcnt(6)
    v_mfma_f32_32x32x16_bf16 v[44:59], v[96:99], v[84:87], v[44:59]
    s_cmp_lg_u32 s23, 3
    s_cbranch_scc1 ng_15
    v_mfma_f32_32x32x16_bf16 v[60:75], v[76:79], v[84:87], v[60:75]
ng_15:
    ds_read_b128 v[84:87], v30 offset:0
    ds_read_b64_tr_b16 v[96:97], v32 offset:15360
    ds_read_b64_tr_b16 v[98:99], v32 offset:15520
    s_waitcnt lgkmcnt(6)
    v_mfma_f32_32x32x16_bf16 v[44:59], v[100:103], v[88:91], v[44:59]
    s_cmp_lg_u32 s23, 0
    s_cbranch_scc1 ng_16
    v_mfma_f32_32x32x16_bf16 v[60:75], v[80:83], v[88:91], v[60:75]
ng_16:
    ds_read_b128 v[88:91], v31 offset:0
    ds_read_b64_tr_b16 v[100:101], v32 offset:17920
    ds_read_b64_tr_b16 v[102:103], v32 offset:18080
    s_waitcnt lgkmcnt(6)
    v_mfma_f32_32x32x16_bf16 v[44:59], v[104:107], v[92:95], v[44:59]
    s_cmp_lg_u32 s23, 1
    s_cbranch_scc1 ng_17
    v_mfma_f32_32x32x16_bf16 v[60:75], v[80:83], v[92:95], v[60:75]
ng_17:
    s_waitcnt lgkmcnt(3)
    v_mfma_f32_32x32x16_bf16 v[44:59], v[96:99], v[84:87], v[44:59]
    s_cmp_lg_u32 s23, 2
    s_cbranch_scc1 ng_18
    v_mfma_f32_32x32x16_bf16 v[60:75], v[80:83], v[84:87], v[60:75]
ng_18:
    s_waitcnt lgkmcnt(0)
    v_mfma_f32_32x32x16_bf16 v[44:59], v[100:103], v[88:91], v[44:59]
    s_cmp_lg_u32 s23, 3
    s_cbranch_scc1 ng_19
    v_mfma_f32_32x32x16_bf16 v[60:75], v[80:83], v[88:91], v[60:75]
ng_19:
    v_mov_b32 v2, 162416
    v_mov_b32 v3, 1
    s_mov_b64 exec, 1
    ds_add_u32 v2, v3
    s_mov_b64 exec, -1
    s_waitcnt vmcnt(0)
    v_mov_b32 v2, 162436
    v_mov_b32 v3, 1
    s_mov_b64 exec, 1
    ds_add_u32 v2, v3
    s_mov_b64 exec, -1
    v_mov_b32 v2, 162436
    s_mov_b32 s43, 0
lw_20:
    ds_read_b32 v3, v2
    s_waitcnt lgkmcnt(0)
    v_readfirstlane_b32 s42, v3
    s_nop 3
    s_cmp_ge_u32 s42, 8
    s_cbranch_scc1 lwd_21
    s_add_u32 s43, s43, 1
    s_cmp_lt_u32 s43, 320000
    s_cbranch_scc0 lwd_21
    s_branch lw_20
lwd_21:
    s_add_u32 s94, s97, 1
    s_sub_u32 s92, s94, 5
    s_cmp_ge_u32 s94, 5
    s_cselect_b32 s94, s92, s94
    s_lshl_b32 s92, s94, 8
    s_mul_i32 s93, s94, 163840
    v_add_u32 v2, s92, v33
    ds_read_b128 v[76:79], v2
    ds_read_b128 v[80:83], v2 offset:128
    ds_read_b128 v[84:87], v24 offset:36864
    ds_read_b64_tr_b16 v[96:97], v32 offset:36864
    ds_read_b64_tr_b16 v[98:99], v32 offset:37024
    ds_read_b128 v[88:91], v25 offset:36864
    ds_read_b64_tr_b16 v[100:101], v32 offset:39424
    ds_read_b64_tr_b16 v[102:103], v32 offset:39584
    ds_read_b128 v[92:95], v26 offset:36864
    ds_read_b64_tr_b16 v[104:105], v32 offset:41984
    ds_read_b64_tr_b16 v[106:107], v32 offset:42144
    s_waitcnt lgkmcnt(6)
    v_mfma_f32_32x32x16_bf16 v[44:59], v[96:99], v[84:87], v[44:59]
    s_cmp_lg_u32 s23, 0
    s_cbranch_scc1 ng_22
    v_mfma_f32_32x32x16_bf16 v[60:75], v[76:79], v[84:87], v[60:75]
ng_22:
    ds_read_b128 v[84:87], v27 offset:36864
    ds_read_b64_tr_b16 v[96:97], v32 offset:44544
    ds_read_b64_tr_b16 v[98:99], v32 offset:44704
    s_waitcnt lgkmcnt(6)
    v_mfma_f32_32x32x16_bf16 v[44:59], v[100:103], v[88:91], v[44:59]
    s_cmp_lg_u32 s23, 1
    s_cbranch_scc1 ng_23
    v_mfma_f32_32x32x16_bf16 v[60:75], v[76:79], v[88:91], v[60:75]
ng_23:
    ds_read_b128 v[88:91], v28 offset:36864
    ds_read_b64_tr_b16 v[100:101], v32 offset:47104
    ds_read_b64_tr_b16 v[102:103], v32 offset:47264
    s_waitcnt lgkmcnt(6)
    v_mfma_f32_32x32x16_bf16 v[44:59], v[104:107], v[92:95], v[44:59]
    s_cmp_lg_u32 s23, 2
    s_cbranch_scc1 ng_24
    v_mfma_f32_32x32x16_bf16 v[60:75], v[76:79], v[92:95], v[60:75]
ng_24:
    ds_read_b128 v[92:95], v29 offset:36864
    ds_read_b64_tr_b16 v[104:105], v32 offset:49664
    ds_read_b64_tr_b16 v[106:107], v32 offset:49824
    s_waitcnt lgkmcnt(6)
    v_mfma_f32_32x32x16_bf16 v[44:59], v[96:99], v[84:87], v[44:59]
    s_cmp_lg_u32 s23, 3
    s_cbranch_scc1 ng_25
    v_mfma_f32_32x32x16_bf16 v[60:75], v[76:79], v[84:87], v[60:75]
ng_25:
    ds_read_b128 v[84:87], v30 offset:36864
    ds_read_b64_tr_b16 v[96:97], v32 offset:52224
    ds_read_b64_tr_b16 v[98:99], v32 offset:52384
    s_waitcnt lgkmcnt(6)
    v_mfma_f32_32x32x16_bf16 v[44:59], v[100:103], v[88:91], v[44:59]
    s_cmp_lg_u32 s23, 0
    s_cbranch_scc1 ng_26
    v_mfma_f32_32x32x16_bf16 v[60:75], v[80:83], v[88:91], v[60:75]
ng_26:
    ds_read_b128 v[88:91], v31 offset:36864
    ds_read_b64_tr_b16 v[100:101], v32 offset:54784
    ds_read_b64_tr_b16 v[102:103], v32 offset:54944
    s_waitcnt lgkmcnt(6)
    v_mfma_f32_32x32x16_bf16 v[44:59], v[104:107], v[92:95], v[44:59]
    s_cmp_lg_u32 s23, 1
    s_cbranch_scc1 ng_27
    v_mfma_f32_32x32x16_bf16 v[60:75], v[80:83], v[92:95], v[60:75]
ng_27:
    s_waitcnt lgkmcnt(3)
    v_mfma_f32_32x32x16_bf16 v[44:59], v[96:99], v[84:87], v[44:59]
    s_cmp_lg_u32 s23, 2
    s_cbranch_scc1 ng_28
    v_mfma_f32_32x32x16_bf16 v[60:75], v[80:83], v[84:87], v[60:75]
ng_28:
    s_waitcnt lgkmcnt(0)
    v_mfma_f32_32x32x16_bf16 v[44:59], v[100:103], v[88:91], v[44:59]
    s_cmp_lg_u32 s23, 3
    s_cbranch_scc1 ng_29
    v_mfma_f32_32x32x16_bf16 v[60:75], v[80:83], v[88:91], v[60:75]
ng_29:
    v_mov_b32 v2, 162420
    v_mov_b32 v3, 1
    s_mov_b64 exec, 1
    ds_add_u32 v2, v3
    s_mov_b64 exec, -1
    v_lshlrev_b32 v139, 4, v1
    v_and_b32 v2, 31, v1
    v_mul_u32_u24 v2, 160, v2
    v_lshrrev_b32 v3, 5, v1
    v_lshlrev_b32 v3, 3, v3
    v_add_u32 v2, v2, v3
    s_mul_i32 s28, s23, 40
    s_mul_i32 s29, s24, 5120
    s_add_u32 s28, s28, s29
    s_add_u32 s28, s28, 12288
    v_add_u32 v129, s28, v2
    s_add_u32 s28, s22, 0
    s_lshl_b32 s28, s28, 2
    v_lshrrev_b32 v2, 4, v1
    v_add_u32 v2, s28, v2
    v_mul_u32_u24 v3, 6554, v2
    v_lshrrev_b32 v3, 16, v3
    v_mul_u32_u24 v164, 10, v3
    v_sub_u32 v2, v2, v164
    v_and_b32 v164, 15, v1
    v_lshl_add_u32 v165, v3, 4, v164
    v_mul_u32_u24 v165, 160, v165
    v_lshl_add_u32 v130, v2, 4, v165
    v_add_u32 v130, 12288, v130
    v_mul_u32_u24 v3, 20480, v3
    v_lshl_add_u32 v3, v2, 8, v3
    v_lshl_add_u32 v131, v164, 4, v3
    s_add_u32 s28, s22, 8
    s_lshl_b32 s28, s28, 2
    v_lshrrev_b32 v2, 4, v1
    v_add_u32 v2, s28, v2
    v_mul_u32_u24 v3, 6554, v2
    v_lshrrev_b32 v3, 16, v3
    v_mul_u32_u24 v164, 10, v3
    v_sub_u32 v2, v2, v164
    v_and_b32 v164, 15, v1
    v_lshl_add_u32 v165, v3, 4, v164
    v_mul_u32_u24 v165, 160, v165
    v_lshl_add_u32 v132, v2, 4, v165
    v_add_u32 v132, 12288, v132
    v_mul_u32_u24 v3, 20480, v3
    v_lshl_add_u32 v3, v2, 8, v3
    v_lshl_add_u32 v133, v164, 4, v3
    v_and_b32 v2, 15, v1
    s_lshl_b32 s29, s23, 4
    s_lshl_b32 s28, s20, 6
    s_add_u32 s28, s28, s29
    v_add_u32 v3, s28, v2
    v_mul_lo_u32 v3, v3, s26
    v_lshrrev_b32 v164, 4, v1
    v_lshlrev_b32 v165, 3, v164
    v_add_u32 v3, v3, v165
    s_mul_i32 s28, s21, 160
    v_add_u32 v134, s28, v3
    v_lshlrev_b32 v2, 2, v2
    s_lshl_b32 s28, s23, 6
    s_add_u32 s28, s28, 162048
    v_add_u32 v137, s28, v2
    v_lshrrev_b32 v2, 5, v1
    v_lshlrev_b32 v2, 4, v2
    v_bfe_u32 v3, v1, 4, 1
    v_lshlrev_b32 v3, 2, v3
    v_add_u32 v2, v2, v3
    v_bfe_u32 v3, v1, 2, 2
    v_add_u32 v2, v2, v3
    v_mul_u32_u24 v2, 160, v2
    v_and_b32 v3, 3, v1
    v_lshlrev_b32 v3, 3, v3
    v_add_u32 v2, v2, v3
    s_mul_i32 s28, s24, 51200
    s_add_u32 s28, s28, 56576
    v_add_u32 v135, s28, v2
    v_bfe_u32 v2, v1, 2, 4
    v_lshlrev_b32 v2, 7, v2
    v_add_u32 v2, v2, v3
    s_lshl_b32 s28, s23, 5
    s_add_u32 s28, s28, 36864
    v_add_u32 v136, s28, v2
    s_mul_i32 s28, s22, 3072
    s_add_u32 s28, s28, 0
    v_add_u32 v138, s28, v139
    v_add_u32 v24, 73728, v24
    v_add_u32 v25, 73728, v25
    v_add_u32 v26, 73728, v26
    v_add_u32 v27, 73728, v27
    v_add_u32 v28, 73728, v28
    v_add_u32 v29, 73728, v29
    v_add_u32 v30, 73728, v30
    v_add_u32 v31, 73728, v31
    v_add_u32 v32, 73728, v32
    v_mov_b32 v2, 162440
    s_mov_b32 s43, 0
lw_30:
    ds_read_b32 v3, v2
    s_waitcnt lgkmcnt(0)
    v_readfirstlane_b32 s42, v3
    s_nop 3
    s_cmp_ge_u32 s42, 3
    s_cbranch_scc1 lwd_31
    s_add_u32 s43, s43, 1
    s_cmp_lt_u32 s43, 320000
    s_cbranch_scc0 lwd_31
    s_sleep 1
    s_branch lw_30
lwd_31:
    s_add_u32 s94, s97, 2
    s_sub_u32 s92, s94, 5
    s_cmp_ge_u32 s94, 5
    s_cselect_b32 s94, s92, s94
    s_lshl_b32 s92, s94, 8
    s_mul_i32 s93, s94, 163840
    v_add_u32 v2, s92, v33
    ds_read_b128 v[76:79], v2
    ds_read_b128 v[80:83], v2 offset:128
    ds_read_b128 v[84:87], v24 offset:0
    ds_read_b64_tr_b16 v[96:97], v32 offset:0
    ds_read_b64_tr_b16 v[98:99], v32 offset:160
    ds_read_b128 v[88:91], v25 offset:0
    ds_read_b64_tr_b16 v[100:101], v32 offset:2560
    ds_read_b64_tr_b16 v[102:103], v32 offset:2720
    ds_read_b128 v[92:95], v26 offset:0
    ds_read_b64_tr_b16 v[104:105], v32 offset:5120
    ds_read_b64_tr_b16 v[106:107], v32 offset:5280
    s_waitcnt lgkmcnt(6)
    v_mfma_f32_32x32x16_bf16 v[44:59], v[96:99], v[84:87], v[44:59]
    s_cmp_lg_u32 s23, 0
    s_cbranch_scc1 ng_32
    v_mfma_f32_32x32x16_bf16 v[60:75], v[76:79], v[84:87], v[60:75]
ng_32:
    ds_read_b128 v[84:87], v27 offset:0
    ds_read_b64_tr_b16 v[96:97], v32 offset:7680
    ds_read_b64_tr_b16 v[98:99], v32 offset:7840
    s_waitcnt lgkmcnt(6)
    v_mfma_f32_32x32x16_bf16 v[44:59], v[100:103], v[88:91], v[44:59]
    s_cmp_lg_u32 s23, 1
    s_cbranch_scc1 ng_33
    v_mfma_f32_32x32x16_bf16 v[60:75], v[76:79], v[88:91], v[60:75]
ng_33:
    ds_read_b128 v[88:91], v28 offset:0
    ds_read_b64_tr_b16 v[100:101], v32 offset:10240
    ds_read_b64_tr_b16 v[102:103], v32 offset:10400
    s_waitcnt lgkmcnt(6)
    v_mfma_f32_32x32x16_bf16 v[44:59], v[104:107], v[92:95], v[44:59]
    s_cmp_lg_u32 s23, 2
    s_cbranch_scc1 ng_34
    v_mfma_f32_32x32x16_bf16 v[60:75], v[76:79], v[92:95], v[60:75]
ng_34:
    ds_read_b128 v[92:95], v29 offset:0
    ds_read_b64_tr_b16 v[104:105], v32 offset:12800
    ds_read_b64_tr_b16 v[106:107], v32 offset:12960
    s_waitcnt lgkmcnt(6)
    v_mfma_f32_32x32x16_bf16 v[44:59], v[96:99], v[84:87], v[44:59]
    s_cmp_lg_u32 s23, 3
    s_cbranch_scc1 ng_35
    v_mfma_f32_32x32x16_bf16 v[60:75], v[76:79], v[84:87], v[60:75]
ng_35:
    ds_read_b128 v[84:87], v30 offset:0
    ds_read_b64_tr_b16 v[96:97], v32 offset:15360
    ds_read_b64_tr_b16 v[98:99], v32 offset:15520
    s_waitcnt lgkmcnt(6)
    v_mfma_f32_32x32x16_bf16 v[44:59], v[100:103], v[88:91], v[44:59]
    s_cmp_lg_u32 s23, 0
    s_cbranch_scc1 ng_36
    v_mfma_f32_32x32x16_bf16 v[60:75], v[80:83], v[88:91], v[60:75]
ng_36:
    ds_read_b128 v[88:91], v31 offset:0
    ds_read_b64_tr_b16 v[100:101], v32 offset:17920
    ds_read_b64_tr_b16 v[102:103], v32 offset:18080
    s_waitcnt lgkmcnt(6)
    v_mfma_f32_32x32x16_bf16 v[44:59], v[104:107], v[92:95], v[44:59]
    s_cmp_lg_u32 s23, 1
    s_cbranch_scc1 ng_37
    v_mfma_f32_32x32x16_bf16 v[60:75], v[80:83], v[92:95], v[60:75]
ng_37:
    s_waitcnt lgkmcnt(3)
    v_mfma_f32_32x32x16_bf16 v[44:59], v[96:99], v[84:87], v[44:59]
    s_cmp_lg_u32 s23, 2
    s_cbranch_scc1 ng_38
    v_mfma_f32_32x32x16_bf16 v[60:75], v[80:83], v[84:87], v[60:75]
ng_38:
    s_waitcnt lgkmcnt(0)
    v_mfma_f32_32x32x16_bf16 v[44:59], v[100:103], v[88:91], v[44:59]
    s_cmp_lg_u32 s23, 3
    s_cbranch_scc1 ng_39
    v_mfma_f32_32x32x16_bf16 v[60:75], v[80:83], v[88:91], v[60:75]
ng_39:
    v_subrev_u32 v24, 73728, v24
    v_subrev_u32 v25, 73728, v25
    v_subrev_u32 v26, 73728, v26
    v_subrev_u32 v27, 73728, v27
    v_subrev_u32 v28, 73728, v28
    v_subrev_u32 v29, 73728, v29
    v_subrev_u32 v30, 73728, v30
    v_subrev_u32 v31, 73728, v31
    v_subrev_u32 v32, 73728, v32
    v_mov_b32 v2, 162444
    s_mov_b32 s43, 0
lw_40:
    ds_read_b32 v3, v2
    s_waitcnt lgkmcnt(0)
    v_readfirstlane_b32 s42, v3
    s_nop 3
    s_cmp_ge_u32 s42, 3
    s_cbranch_scc1 lwd_41
    s_add_u32 s43, s43, 1
    s_cmp_lt_u32 s43, 320000
    s_cbranch_scc0 lwd_41
    s_sleep 1
    s_branch lw_40
lwd_41:
    s_add_u32 s94, s97, 3
    s_sub_u32 s92, s94, 5
    s_cmp_ge_u32 s94, 5
    s_cselect_b32 s94, s92, s94
    s_lshl_b32 s92, s94, 8
    s_mul_i32 s93, s94, 163840
    v_add_u32 v2, s92, v33
    ds_read_b128 v[76:79], v2
    ds_read_b128 v[80:83], v2 offset:128
    ds_read_b128 v[84:87], v24 offset:0
    ds_read_b64_tr_b16 v[96:97], v32 offset:0
    ds_read_b64_tr_b16 v[98:99], v32 offset:160
    ds_read_b128 v[88:91], v25 offset:0
    ds_read_b64_tr_b16 v[100:101], v32 offset:2560
    ds_read_b64_tr_b16 v[102:103], v32 offset:2720
    ds_read_b128 v[92:95], v26 offset:0
    ds_read_b64_tr_b16 v[104:105], v32 offset:5120
    ds_read_b64_tr_b16 v[106:107], v32 offset:5280
    s_waitcnt lgkmcnt(6)
    v_mfma_f32_32x32x16_bf16 v[44:59], v[96:99], v[84:87], v[44:59]
    s_cmp_lg_u32 s23, 0
    s_cbranch_scc1 ng_42
    v_mfma_f32_32x32x16_bf16 v[60:75], v[76:79], v[84:87], v[60:75]
ng_42:
    ds_read_b128 v[84:87], v27 offset:0
    ds_read_b64_tr_b16 v[96:97], v32 offset:7680
    ds_read_b64_tr_b16 v[98:99], v32 offset:7840
    s_waitcnt lgkmcnt(6)
    v_mfma_f32_32x32x16_bf16 v[44:59], v[100:103], v[88:91], v[44:59]
    s_cmp_lg_u32 s23, 1
    s_cbranch_scc1 ng_43
    v_mfma_f32_32x32x16_bf16 v[60:75], v[76:79], v[88:91], v[60:75]
ng_43:
    ds_read_b128 v[88:91], v28 offset:0
    ds_read_b64_tr_b16 v[100:101], v32 offset:10240
    ds_read_b64_tr_b16 v[102:103], v32 offset:10400
    s_waitcnt lgkmcnt(6)
    v_mfma_f32_32x32x16_bf16 v[44:59], v[104:107], v[92:95], v[44:59]
    s_cmp_lg_u32 s23, 2
    s_cbranch_scc1 ng_44
    v_mfma_f32_32x32x16_bf16 v[60:75], v[76:79], v[92:95], v[60:75]
ng_44:
    ds_read_b128 v[92:95], v29 offset:0
    ds_read_b64_tr_b16 v[104:105], v32 offset:12800
    ds_read_b64_tr_b16 v[106:107], v32 offset:12960
    s_waitcnt lgkmcnt(6)
    v_mfma_f32_32x32x16_bf16 v[44:59], v[96:99], v[84:87], v[44:59]
    s_cmp_lg_u32 s23, 3
    s_cbranch_scc1 ng_45
    v_mfma_f32_32x32x16_bf16 v[60:75], v[76:79], v[84:87], v[60:75]
ng_45:
    ds_read_b128 v[84:87], v30 offset:0
    ds_read_b64_tr_b16 v[96:97], v32 offset:15360
    ds_read_b64_tr_b16 v[98:99], v32 offset:15520
    s_waitcnt lgkmcnt(6)
    v_mfma_f32_32x32x16_bf16 v[44:59], v[100:103], v[88:91], v[44:59]
    s_cmp_lg_u32 s23, 0
    s_cbranch_scc1 ng_46
    v_mfma_f32_32x32x16_bf16 v[60:75], v[80:83], v[88:91], v[60:75]
ng_46:
    ds_read_b128 v[88:91], v31 offset:0
    ds_read_b64_tr_b16 v[100:101], v32 offset:17920
    ds_read_b64_tr_b16 v[102:103], v32 offset:18080
    s_waitcnt lgkmcnt(6)
    v_mfma_f32_32x32x16_bf16 v[44:59], v[104:107], v[92:95], v[44:59]
    s_cmp_lg_u32 s23, 1
    s_cbranch_scc1 ng_47
    v_mfma_f32_32x32x16_bf16 v[60:75], v[80:83], v[92:95], v[60:75]
ng_47:
    s_waitcnt lgkmcnt(3)
    v_mfma_f32_32x32x16_bf16 v[44:59], v[96:99], v[84:87], v[44:59]
    s_cmp_lg_u32 s23, 2
    s_cbranch_scc1 ng_48
    v_mfma_f32_32x32x16_bf16 v[60:75], v[80:83], v[84:87], v[60:75]
ng_48:
    s_waitcnt lgkmcnt(0)
    v_mfma_f32_32x32x16_bf16 v[44:59], v[100:103], v[88:91], v[44:59]
    s_cmp_lg_u32 s23, 3
    s_cbranch_scc1 ng_49
    v_mfma_f32_32x32x16_bf16 v[60:75], v[80:83], v[88:91], v[60:75]
ng_49:
    v_mov_b32 v2, 162448
    s_mov_b32 s43, 0
lw_50:
    ds_read_b32 v3, v2
    s_waitcnt lgkmcnt(0)
    v_readfirstlane_b32 s42, v3
    s_nop 3
    s_cmp_ge_u32 s42, 3
    s_cbranch_scc1 lwd_51
    s_add_u32 s43, s43, 1
    s_cmp_lt_u32 s43, 320000
    s_cbranch_scc0 lwd_51
    s_sleep 1
    s_branch lw_50
lwd_51:
    s_add_u32 s94, s97, 4
    s_sub_u32 s92, s94, 5
    s_cmp_ge_u32 s94, 5
    s_cselect_b32 s94, s92, s94
    s_lshl_b32 s92, s94, 8
    s_mul_i32 s93, s94, 163840
    v_add_u32 v2, s92, v33
    ds_read_b128 v[76:79], v2
    ds_read_b128 v[80:83], v2 offset:128
    ds_read_b128 v[84:87], v24 offset:36864
    ds_read_b64_tr_b16 v[96:97], v32 offset:36864
    ds_read_b64_tr_b16 v[98:99], v32 offset:37024
    ds_read_b128 v[88:91], v25 offset:36864
    ds_read_b64_tr_b16 v[100:101], v32 offset:39424
    ds_read_b64_tr_b16 v[102:103], v32 offset:39584
    ds_read_b128 v[92:95], v26 offset:36864
    ds_read_b64_tr_b16 v[104:105], v32 offset:41984
    ds_read_b64_tr_b16 v[106:107], v32 offset:42144
    s_waitcnt lgkmcnt(6)
    v_mfma_f32_32x32x16_bf16 v[44:59], v[96:99], v[84:87], v[44:59]
    s_cmp_lg_u32 s23, 0
    s_cbranch_scc1 ng_52
    v_mfma_f32_32x32x16_bf16 v[60:75], v[76:79], v[84:87], v[60:75]
ng_52:
    ds_read_b128 v[84:87], v27 offset:36864
    ds_read_b64_tr_b16 v[96:97], v32 offset:44544
    ds_read_b64_tr_b16 v[98:99], v32 offset:44704
    s_waitcnt lgkmcnt(6)
    v_mfma_f32_32x32x16_bf16 v[44:59], v[100:103], v[88:91], v[44:59]
    s_cmp_lg_u32 s23, 1
    s_cbranch_scc1 ng_53
    v_mfma_f32_32x32x16_bf16 v[60:75], v[76:79], v[88:91], v[60:75]
ng_53:
    ds_read_b128 v[88:91], v28 offset:36864
    ds_read_b64_tr_b16 v[100:101], v32 offset:47104
    ds_read_b64_tr_b16 v[102:103], v32 offset:47264
    s_waitcnt lgkmcnt(6)
    v_mfma_f32_32x32x16_bf16 v[44:59], v[104:107], v[92:95], v[44:59]
    s_cmp_lg_u32 s23, 2
    s_cbranch_scc1 ng_54
    v_mfma_f32_32x32x16_bf16 v[60:75], v[76:79], v[92:95], v[60:75]
ng_54:
    ds_read_b128 v[92:95], v29 offset:36864
    ds_read_b64_tr_b16 v[104:105], v32 offset:49664
    ds_read_b64_tr_b16 v[106:107], v32 offset:49824
    s_waitcnt lgkmcnt(6)
    v_mfma_f32_32x32x16_bf16 v[44:59], v[96:99], v[84:87], v[44:59]
    s_cmp_lg_u32 s23, 3
    s_cbranch_scc1 ng_55
    v_mfma_f32_32x32x16_bf16 v[60:75], v[76:79], v[84:87], v[60:75]
ng_55:
    ds_read_b128 v[84:87], v30 offset:36864
    ds_read_b64_tr_b16 v[96:97], v32 offset:52224
    ds_read_b64_tr_b16 v[98:99], v32 offset:52384
    s_waitcnt lgkmcnt(6)
    v_mfma_f32_32x32x16_bf16 v[44:59], v[100:103], v[88:91], v[44:59]
    s_cmp_lg_u32 s23, 0
    s_cbranch_scc1 ng_56
    v_mfma_f32_32x32x16_bf16 v[60:75], v[80:83], v[88:91], v[60:75]
ng_56:
    ds_read_b128 v[88:91], v31 offset:36864
    ds_read_b64_tr_b16 v[100:101], v32 offset:54784
    ds_read_b64_tr_b16 v[102:103], v32 offset:54944
    s_waitcnt lgkmcnt(6)
    v_mfma_f32_32x32x16_bf16 v[44:59], v[104:107], v[92:95], v[44:59]
    s_cmp_lg_u32 s23, 1
    s_cbranch_scc1 ng_57
    v_mfma_f32_32x32x16_bf16 v[60:75], v[80:83], v[92:95], v[60:75]
ng_57:
    s_waitcnt lgkmcnt(3)
    v_mfma_f32_32x32x16_bf16 v[44:59], v[96:99], v[84:87], v[44:59]
    s_cmp_lg_u32 s23, 2
    s_cbranch_scc1 ng_58
    v_mfma_f32_32x32x16_bf16 v[60:75], v[80:83], v[84:87], v[60:75]
ng_58:
    s_waitcnt lgkmcnt(0)
    v_mfma_f32_32x32x16_bf16 v[44:59], v[100:103], v[88:91], v[44:59]
    s_cmp_lg_u32 s23, 3
    s_cbranch_scc1 ng_59
    v_mfma_f32_32x32x16_bf16 v[60:75], v[80:83], v[88:91], v[60:75]
ng_59:
    v_mov_b32 v2, 162552
    v_mov_b32 v3, 1
    s_mov_b64 exec, 1
    ds_add_u32 v2, v3
    s_mov_b64 exec, -1
    s_mul_i32 s78, s24, 24576
    v_lshlrev_b32 v110, 4, v1
    v_mov_b32 v111, 1
    s_lshl_b32 s28, s24, 4
    s_add_u32 s89, s28, 162304
    s_mul_i32 s29, s23, 3072
    s_add_u32 s82, s78, s29
    v_add_u32 v104, s78, v110
    v_and_b32 v2, 31, v1
    v_lshlrev_b32 v3, 3, v2
    v_add_u32 v3, 1024, v3
    v_mov_b32 v105, 1280
    v_cmp_gt_u32 vcc, 32, v1
    v_min_u32 v164, 20, v2
    v_subrev_u32 v106, 16, v2
    v_cndmask_b32 v105, v105, v3, vcc
    v_add_u32 v105, s78, v105
    v_cmp_lt_u32 vcc, 27, v2
    s_nop 1
    v_cndmask_b32 v164, v164, v106, vcc
    v_lshlrev_b32 v164, 4, v164
    v_lshrrev_b32 v106, 5, v1
    v_mul_u32_u24 v106, 336, v106
    v_add_u32 v106, v106, v164
    v_add_u32 v106, 1296, v106
    v_add_u32 v106, s78, v106
    v_lshlrev_b32 v2, 2, v1
    v_add_u32 v2, 162688, v2
    v_mov_b32 v3, s89
    v_cmp_eq_u32 vcc, 0, v1
    s_nop 1
    v_cndmask_b32 v112, v2, v3, vcc
    v_add_u32 v114, s82, v110
    s_lshl_b32 s28, s22, 2
    s_add_u32 s29, s28, 162496
    v_mov_b32 v3, s29
    v_cndmask_b32 v150, v2, v3, vcc
    s_xor_b32 s28, s28, 16
    s_add_u32 s28, s28, 162496
    v_mov_b32 v151, s28
    s_lshl_b32 s28, s22, 10
    v_lshlrev_b32 v164, 4, v1
    v_add_u32 v164, s28, v164
    v_lshrrev_b32 v165, 1, v164
    v_xor_b32 v34, 4096, v164
    v_xor_b32 v35, 2048, v165
    v_add_u32 v164, 110592, v164
    v_add_u32 v165, 118784, v165
    v_add_u32 v34, 110592, v34
    v_add_u32 v35, 118784, v35
    s_mov_b32 s28, 0x3ea52b5c
    v_mul_f32 v44, s28, v44
    v_mul_f32 v45, s28, v45
    v_mul_f32 v46, s28, v46
    v_mul_f32 v47, s28, v47
    v_mul_f32 v48, s28, v48
    v_mul_f32 v49, s28, v49
    v_mul_f32 v50, s28, v50
    v_mul_f32 v51, s28, v51
    v_mul_f32 v52, s28, v52
    v_mul_f32 v53, s28, v53
    v_mul_f32 v54, s28, v54
    v_mul_f32 v55, s28, v55
    v_cmp_gt_u32 vcc, 32, v1
    v_cvt_pk_bf16_f32 v4, v44, v45
    v_cvt_pk_bf16_f32 v5, v46, v47
    v_cvt_pk_bf16_f32 v6, v48, v49
    v_cvt_pk_bf16_f32 v7, v50, v51
    v_cvt_pk_bf16_f32 v8, v52, v53
    v_cvt_pk_bf16_f32 v9, v54, v55
    ds_write_b128 v164, v[4:7]
    v_cndmask_b32 v8, 0, v8, vcc
    v_cndmask_b32 v9, 0, v9, vcc
    s_lshl_b32 s28, s22, 7
    s_add_u32 s28, s28, 161024
    v_lshlrev_b32 v3, 2, v1
    v_add_u32 v3, s28, v3
    ds_write_b64 v165, v[8:9]
    s_mov_b64 exec, 0xffffffff
    ds_write_b32 v3, v60
    s_mov_b64 exec, -1
    s_lshl_b32 s28, s22, 2
    s_add_u32 s29, s28, 162464
    v_mov_b32 v2, s29
    s_mov_b64 exec, 1
    ds_add_u32 v2, v111
    s_mov_b64 exec, -1
    s_xor_b32 s28, s28, 16
    s_add_u32 s28, s28, 162464
    v_mov_b32 v2, s28
    v_mov_b32 v56, 0
    v_mov_b32 v72, 0
    v_mov_b32 v57, 0
    v_mov_b32 v73, 0
    v_mov_b32 v58, 0
    v_mov_b32 v74, 0
    v_mov_b32 v59, 0
    v_mov_b32 v75, 0
    v_mov_b32 v60, 0
    v_mov_b32 v76, 0
    v_mov_b32 v61, 0
    v_mov_b32 v77, 0
    v_mov_b32 v62, 0
    v_mov_b32 v78, 0
    v_mov_b32 v63, 0
    v_mov_b32 v79, 0
    v_mov_b32 v64, 0
    v_mov_b32 v80, 0
    v_mov_b32 v65, 0
    v_mov_b32 v81, 0
    v_mov_b32 v66, 0
    v_mov_b32 v82, 0
    v_mov_b32 v67, 0
    v_mov_b32 v83, 0
    v_mov_b32 v68, 0
    v_mov_b32 v84, 0
    v_mov_b32 v69, 0
    v_mov_b32 v85, 0
    v_mov_b32 v70, 0
    v_mov_b32 v86, 0
    v_mov_b32 v71, 0
    v_mov_b32 v87, 0
    v_mov_b32 v48, 0
    v_mov_b32 v49, 0
    v_mov_b32 v50, 0
    v_mov_b32 v51, 0
    v_mov_b32 v52, 0
    v_mov_b32 v53, 0
    v_mov_b32 v54, 0
    v_mov_b32 v55, 0
    v_mov_b32 v100, 0
    v_mov_b32 v101, 0
    v_mov_b32 v102, 0
    v_mov_b32 v103, 0
    v_mov_b32 v44, 0
    v_mov_b32 v45, 0
    v_mov_b32 v46, 0
    v_mov_b32 v47, 0
    s_mov_b32 s43, 0
lw_60:
    ds_read_b32 v3, v2
    s_waitcnt lgkmcnt(0)
    v_readfirstlane_b32 s42, v3
    s_nop 3
    s_cmp_ge_u32 s42, 1
    s_cbranch_scc1 lwd_61
    s_add_u32 s43, s43, 1
    s_cmp_lt_u32 s43, 320000
    s_cbranch_scc0 lwd_61
    s_branch lw_60
lwd_61:
    ds_read_b128 v[10:13], v34
    ds_read_b64 v[14:15], v35
    s_waitcnt lgkmcnt(0)
    v_mov_b32 v2, 162424
    v_mov_b32 v3, 1
    s_mov_b64 exec, 1
    ds_add_u32 v2, v3
    s_mov_b64 exec, -1
    s_mov_b32 s43, 0
lw_62:
    ds_read_b32 v115, v112
    s_waitcnt lgkmcnt(0)
    v_readfirstlane_b32 s42, v115
    s_nop 3
    s_cmp_ge_u32 s42, 1
    s_cbranch_scc1 lwd_63
    s_add_u32 s43, s43, 1
    s_cmp_lt_u32 s43, 320000
    s_cbranch_scc0 lwd_63
    s_sleep 1
    s_branch lw_62
lwd_63:
    ds_read_b128 v[88:91], v104
    ds_read_b64 v[92:93], v105
    ds_read_b128 v[96:99], v106
    s_waitcnt lgkmcnt(0)
    v_mfma_f32_32x32x16_bf16 v[16:31], v[88:91], v[4:7], 0
    v_mfma_f32_32x32x8_bf16 v[16:31], v[92:93], v[8:9], v[16:31]
    s_mov_b32 s34, 0
    s_mov_b32 s36, 1
    s_mov_b32 s37, 2
    s_mov_b32 s80, 0
    buffer_load_dwordx2 v[140:141], v134, s[4:7], 0 offen offset:0
    buffer_load_dwordx2 v[142:143], v134, s[4:7], 0 offen offset:32
    buffer_load_dwordx2 v[144:145], v134, s[4:7], 0 offen offset:64
    buffer_load_dwordx2 v[146:147], v134, s[4:7], 0 offen offset:96
    buffer_load_dwordx2 v[148:149], v134, s[4:7], 0 offen offset:128
    s_setprio 1
f_attn:
    v_cvt_pk_bf16_f32 v54, v44, v45
    v_cvt_pk_bf16_f32 v55, v46, v47
    v_mfma_f32_32x32x16_bf16 v[32:47], v[88:91], v[10:13], 0
    ds_read_b128 v[88:91], v104 offset:3072
    ds_read_b32 v115, v112 offset:4
    v_exp_f32 v16, v16
    v_exp_f32 v17, v17
    v_exp_f32 v18, v18
    v_exp_f32 v19, v19
    v_cvt_pk_bf16_f32 v48, v16, v17
    v_cvt_pk_bf16_f32 v49, v18, v19
    v_mfma_f32_32x32x16_bf16 v[72:87], v[100:103], v[52:55], v[72:87]
    ds_read_b128 v[100:103], v106 offset:672
    v_exp_f32 v20, v20
    v_exp_f32 v21, v21
    v_exp_f32 v22, v22
    v_exp_f32 v23, v23
    v_cvt_pk_bf16_f32 v50, v20, v21
    v_cvt_pk_bf16_f32 v51, v22, v23
    v_mfma_f32_32x32x8_bf16 v[32:47], v[92:93], v[14:15], v[32:47]
    ds_read_b64 v[92:93], v105 offset:3072
    v_exp_f32 v24, v24
    v_exp_f32 v25, v25
    v_exp_f32 v26, v26
    v_exp_f32 v27, v27
    v_cvt_pk_bf16_f32 v52, v24, v25
    v_cvt_pk_bf16_f32 v53, v26, v27
    s_waitcnt lgkmcnt(4)
    v_mfma_f32_32x32x16_bf16 v[56:71], v[96:99], v[48:51], v[56:71]
    v_exp_f32 v28, v28
    v_exp_f32 v29, v29
    v_exp_f32 v30, v30
    v_exp_f32 v31, v31
    v_cvt_pk_bf16_f32 v54, v28, v29
    v_cvt_pk_bf16_f32 v55, v30, v31
    s_waitcnt lgkmcnt(0)
    v_mfma_f32_32x32x16_bf16 v[16:31], v[88:91], v[4:7], 0
    s_cmp_eq_u32 s34, 0
    s_cbranch_scc1 ifw_64
    ds_add_u32 v112, v111 offset:44
ifw_64:
    v_readfirstlane_b32 s42, v115
    s_nop 3
    s_cmp_ge_u32 s42, s36
    s_cbranch_scc1 ok_66
    s_mov_b32 s43, 0
rt_67:
    s_sleep 1
    ds_read_b32 v115, v112 offset:4
    s_waitcnt lgkmcnt(0)
    v_readfirstlane_b32 s42, v115
    s_add_u32 s43, s43, 1
    s_cmp_ge_u32 s43, 320000
    s_cbranch_scc1 ok_66
    s_cmp_lt_u32 s42, s36
    s_cbranch_scc1 rt_67
ok_66:
nf_65:
    v_exp_f32 v32, v32
    v_exp_f32 v33, v33
    v_exp_f32 v34, v34
    v_exp_f32 v35, v35
    v_cvt_pk_bf16_f32 v48, v32, v33
    v_cvt_pk_bf16_f32 v49, v34, v35
    v_mfma_f32_32x32x16_bf16 v[56:71], v[100:103], v[52:55], v[56:71]
    v_exp_f32 v36, v36
    v_exp_f32 v37, v37
    v_exp_f32 v38, v38
    v_exp_f32 v39, v39
    v_cvt_pk_bf16_f32 v50, v36, v37
    v_cvt_pk_bf16_f32 v51, v38, v39
    v_mfma_f32_32x32x8_bf16 v[16:31], v[92:93], v[8:9], v[16:31]
    v_exp_f32 v40, v40
    v_exp_f32 v41, v41
    v_exp_f32 v42, v42
    v_exp_f32 v43, v43
    v_cvt_pk_bf16_f32 v52, v40, v41
    v_cvt_pk_bf16_f32 v53, v42, v43
    v_mfma_f32_32x32x16_bf16 v[72:87], v[96:99], v[48:51], v[72:87]
    ds_read_b128 v[96:99], v106 offset:3072
    v_exp_f32 v44, v44
    v_exp_f32 v45, v45
    v_exp_f32 v46, v46
    v_exp_f32 v47, v47
    v_cvt_pk_bf16_f32 v54, v44, v45
    v_cvt_pk_bf16_f32 v55, v46, v47
    v_mfma_f32_32x32x16_bf16 v[32:47], v[88:91], v[10:13], 0
    ds_read_b128 v[88:91], v104 offset:6144
    ds_read_b32 v128, v151
    v_exp_f32 v16, v16
    v_exp_f32 v17, v17
    v_exp_f32 v18, v18
    v_exp_f32 v19, v19
    v_cvt_pk_bf16_f32 v48, v16, v17
    v_cvt_pk_bf16_f32 v49, v18, v19
    v_mfma_f32_32x32x16_bf16 v[72:87], v[100:103], v[52:55], v[72:87]
    ds_read_b128 v[100:103], v106 offset:3744
    v_exp_f32 v20, v20
    v_exp_f32 v21, v21
    v_exp_f32 v22, v22
    v_exp_f32 v23, v23
    v_cvt_pk_bf16_f32 v50, v20, v21
    v_cvt_pk_bf16_f32 v51, v22, v23
    v_mfma_f32_32x32x8_bf16 v[32:47], v[92:93], v[14:15], v[32:47]
    ds_read_b64 v[92:93], v105 offset:6144
    v_exp_f32 v24, v24
    v_exp_f32 v25, v25
    v_exp_f32 v26, v26
    v_exp_f32 v27, v27
    v_cvt_pk_bf16_f32 v52, v24, v25
    v_cvt_pk_bf16_f32 v53, v26, v27
    s_waitcnt lgkmcnt(4)
    v_mfma_f32_32x32x16_bf16 v[56:71], v[96:99], v[48:51], v[56:71]
    v_exp_f32 v28, v28
    v_exp_f32 v29, v29
    v_exp_f32 v30, v30
    v_exp_f32 v31, v31
    v_cvt_pk_bf16_f32 v54, v28, v29
    v_cvt_pk_bf16_f32 v55, v30, v31
    s_waitcnt lgkmcnt(0)
    v_mfma_f32_32x32x16_bf16 v[16:31], v[88:91], v[4:7], 0
    v_readfirstlane_b32 s42, v128
    s_nop 1
    s_cmp_gt_u32 s80, s42
    s_cbranch_scc1 pa_68
    s_setprio 2
    s_branch pb_69
pa_68:
    s_setprio 1
pb_69:
    v_exp_f32 v32, v32
    v_exp_f32 v33, v33
    v_exp_f32 v34, v34
    v_exp_f32 v35, v35
    v_cvt_pk_bf16_f32 v48, v32, v33
    v_cvt_pk_bf16_f32 v49, v34, v35
    v_mfma_f32_32x32x16_bf16 v[56:71], v[100:103], v[52:55], v[56:71]
    v_exp_f32 v36, v36
    v_exp_f32 v37, v37
    v_exp_f32 v38, v38
    v_exp_f32 v39, v39
    v_cvt_pk_bf16_f32 v50, v36, v37
    v_cvt_pk_bf16_f32 v51, v38, v39
    v_mfma_f32_32x32x8_bf16 v[16:31], v[92:93], v[8:9], v[16:31]
    v_exp_f32 v40, v40
    v_exp_f32 v41, v41
    v_exp_f32 v42, v42
    v_exp_f32 v43, v43
    v_cvt_pk_bf16_f32 v52, v40, v41
    v_cvt_pk_bf16_f32 v53, v42, v43
    v_mfma_f32_32x32x16_bf16 v[72:87], v[96:99], v[48:51], v[72:87]
    ds_read_b128 v[96:99], v106 offset:6144
    v_exp_f32 v44, v44
    v_exp_f32 v45, v45
    v_exp_f32 v46, v46
    v_exp_f32 v47, v47
    s_add_u32 s80, s80, 1
    v_mov_b32 v115, s80
    ds_write_b32 v150, v115
    v_cvt_pk_bf16_f32 v54, v44, v45
    v_cvt_pk_bf16_f32 v55, v46, v47
    v_mfma_f32_32x32x16_bf16 v[32:47], v[88:91], v[10:13], 0
    ds_read_b128 v[88:91], v104 offset:9216
    ds_read_b32 v115, v112 offset:8
    v_exp_f32 v16, v16
    v_exp_f32 v17, v17
    v_exp_f32 v18, v18
    v_exp_f32 v19, v19
    v_cvt_pk_bf16_f32 v48, v16, v17
    v_cvt_pk_bf16_f32 v49, v18, v19
    v_mfma_f32_32x32x16_bf16 v[72:87], v[100:103], v[52:55], v[72:87]
    ds_read_b128 v[100:103], v106 offset:6816
    v_exp_f32 v20, v20
    v_exp_f32 v21, v21
    v_exp_f32 v22, v22
    v_exp_f32 v23, v23
    v_cvt_pk_bf16_f32 v50, v20, v21
    v_cvt_pk_bf16_f32 v51, v22, v23
    v_mfma_f32_32x32x8_bf16 v[32:47], v[92:93], v[14:15], v[32:47]
    ds_read_b64 v[92:93], v105 offset:9216
    v_exp_f32 v24, v24
    v_exp_f32 v25, v25
    v_exp_f32 v26, v26
    v_exp_f32 v27, v27
    v_cvt_pk_bf16_f32 v52, v24, v25
    v_cvt_pk_bf16_f32 v53, v26, v27
    s_waitcnt lgkmcnt(4)
    v_mfma_f32_32x32x16_bf16 v[56:71], v[96:99], v[48:51], v[56:71]
    v_exp_f32 v28, v28
    v_exp_f32 v29, v29
    v_exp_f32 v30, v30
    v_exp_f32 v31, v31
    v_cvt_pk_bf16_f32 v54, v28, v29
    v_cvt_pk_bf16_f32 v55, v30, v31
    s_waitcnt lgkmcnt(0)
    v_mfma_f32_32x32x16_bf16 v[16:31], v[88:91], v[4:7], 0
    ds_add_u32 v112, v111 offset:32
    v_readfirstlane_b32 s42, v115
    s_nop 3
    s_cmp_ge_u32 s42, s36
    s_cbranch_scc1 ok_71
    s_mov_b32 s43, 0
rt_72:
    s_sleep 1
    ds_read_b32 v115, v112 offset:8
    s_waitcnt lgkmcnt(0)
    v_readfirstlane_b32 s42, v115
    s_add_u32 s43, s43, 1
    s_cmp_ge_u32 s43, 320000
    s_cbranch_scc1 ok_71
    s_cmp_lt_u32 s42, s36
    s_cbranch_scc1 rt_72
ok_71:
nf_70:
    v_exp_f32 v32, v32
    v_exp_f32 v33, v33
    v_exp_f32 v34, v34
    v_exp_f32 v35, v35
    v_cvt_pk_bf16_f32 v48, v32, v33
    v_cvt_pk_bf16_f32 v49, v34, v35
    v_mfma_f32_32x32x16_bf16 v[56:71], v[100:103], v[52:55], v[56:71]
    v_exp_f32 v36, v36
    v_exp_f32 v37, v37
    v_exp_f32 v38, v38
    v_exp_f32 v39, v39
    v_cvt_pk_bf16_f32 v50, v36, v37
    v_cvt_pk_bf16_f32 v51, v38, v39
    v_mfma_f32_32x32x8_bf16 v[16:31], v[92:93], v[8:9], v[16:31]
    v_exp_f32 v40, v40
    v_exp_f32 v41, v41
    v_exp_f32 v42, v42
    v_exp_f32 v43, v43
    v_cvt_pk_bf16_f32 v52, v40, v41
    v_cvt_pk_bf16_f32 v53, v42, v43
    v_mfma_f32_32x32x16_bf16 v[72:87], v[96:99], v[48:51], v[72:87]
    ds_read_b128 v[96:99], v106 offset:9216
    v_exp_f32 v44, v44
    v_exp_f32 v45, v45
    v_exp_f32 v46, v46
    v_exp_f32 v47, v47
    v_cvt_pk_bf16_f32 v54, v44, v45
    v_cvt_pk_bf16_f32 v55, v46, v47
    v_mfma_f32_32x32x16_bf16 v[32:47], v[88:91], v[10:13], 0
    ds_read_b128 v[88:91], v104 offset:12288
    ds_read_b32 v128, v151
    v_exp_f32 v16, v16
    v_exp_f32 v17, v17
    v_exp_f32 v18, v18
    v_exp_f32 v19, v19
    v_cvt_pk_bf16_f32 v48, v16, v17
    v_cvt_pk_bf16_f32 v49, v18, v19
    v_mfma_f32_32x32x16_bf16 v[72:87], v[100:103], v[52:55], v[72:87]
    ds_read_b128 v[100:103], v106 offset:9888
    v_exp_f32 v20, v20
    v_exp_f32 v21, v21
    v_exp_f32 v22, v22
    v_exp_f32 v23, v23
    v_cvt_pk_bf16_f32 v50, v20, v21
    v_cvt_pk_bf16_f32 v51, v22, v23
    v_mfma_f32_32x32x8_bf16 v[32:47], v[92:93], v[14:15], v[32:47]
    ds_read_b64 v[92:93], v105 offset:12288
    v_exp_f32 v24, v24
    v_exp_f32 v25, v25
    v_exp_f32 v26, v26
    v_exp_f32 v27, v27
    v_cvt_pk_bf16_f32 v52, v24, v25
    v_cvt_pk_bf16_f32 v53, v26, v27
    s_waitcnt lgkmcnt(4)
    v_mfma_f32_32x32x16_bf16 v[56:71], v[96:99], v[48:51], v[56:71]
    v_exp_f32 v28, v28
    v_exp_f32 v29, v29
    v_exp_f32 v30, v30
    v_exp_f32 v31, v31
    v_cvt_pk_bf16_f32 v54, v28, v29
    v_cvt_pk_bf16_f32 v55, v30, v31
    s_waitcnt lgkmcnt(0)
    v_mfma_f32_32x32x16_bf16 v[16:31], v[88:91], v[4:7], 0
    v_readfirstlane_b32 s42, v128
    s_nop 1
    s_cmp_gt_u32 s80, s42
    s_cbranch_scc1 pa_73
    s_setprio 2
    s_branch pb_74
pa_73:
    s_setprio 1
pb_74:
    v_exp_f32 v32, v32
    v_exp_f32 v33, v33
    v_exp_f32 v34, v34
    v_exp_f32 v35, v35
    v_cvt_pk_bf16_f32 v48, v32, v33
    v_cvt_pk_bf16_f32 v49, v34, v35
    v_mfma_f32_32x32x16_bf16 v[56:71], v[100:103], v[52:55], v[56:71]
    v_exp_f32 v36, v36
    v_exp_f32 v37, v37
    v_exp_f32 v38, v38
    v_exp_f32 v39, v39
    v_cvt_pk_bf16_f32 v50, v36, v37
    v_cvt_pk_bf16_f32 v51, v38, v39
    v_mfma_f32_32x32x8_bf16 v[16:31], v[92:93], v[8:9], v[16:31]
    v_exp_f32 v40, v40
    v_exp_f32 v41, v41
    v_exp_f32 v42, v42
    v_exp_f32 v43, v43
    v_cvt_pk_bf16_f32 v52, v40, v41
    v_cvt_pk_bf16_f32 v53, v42, v43
    v_mfma_f32_32x32x16_bf16 v[72:87], v[96:99], v[48:51], v[72:87]
    ds_read_b128 v[96:99], v106 offset:12288
    v_exp_f32 v44, v44
    v_exp_f32 v45, v45
    v_exp_f32 v46, v46
    v_exp_f32 v47, v47
    s_add_u32 s80, s80, 1
    v_mov_b32 v115, s80
    ds_write_b32 v150, v115
    v_cvt_pk_bf16_f32 v54, v44, v45
    v_cvt_pk_bf16_f32 v55, v46, v47
    v_mfma_f32_32x32x16_bf16 v[32:47], v[88:91], v[10:13], 0
    ds_read_b128 v[88:91], v104 offset:15360
    ds_read_b32 v115, v112 offset:12
    v_exp_f32 v16, v16
    v_exp_f32 v17, v17
    v_exp_f32 v18, v18
    v_exp_f32 v19, v19
    v_cvt_pk_bf16_f32 v48, v16, v17
    v_cvt_pk_bf16_f32 v49, v18, v19
    v_mfma_f32_32x32x16_bf16 v[72:87], v[100:103], v[52:55], v[72:87]
    ds_read_b128 v[100:103], v106 offset:12960
    v_exp_f32 v20, v20
    v_exp_f32 v21, v21
    v_exp_f32 v22, v22
    v_exp_f32 v23, v23
    v_cvt_pk_bf16_f32 v50, v20, v21
    v_cvt_pk_bf16_f32 v51, v22, v23
    v_mfma_f32_32x32x8_bf16 v[32:47], v[92:93], v[14:15], v[32:47]
    ds_read_b64 v[92:93], v105 offset:15360
    v_exp_f32 v24, v24
    v_exp_f32 v25, v25
    v_exp_f32 v26, v26
    v_exp_f32 v27, v27
    v_cvt_pk_bf16_f32 v52, v24, v25
    v_cvt_pk_bf16_f32 v53, v26, v27
    s_waitcnt lgkmcnt(4)
    v_mfma_f32_32x32x16_bf16 v[56:71], v[96:99], v[48:51], v[56:71]
    v_exp_f32 v28, v28
    v_exp_f32 v29, v29
    v_exp_f32 v30, v30
    v_exp_f32 v31, v31
    v_cvt_pk_bf16_f32 v54, v28, v29
    v_cvt_pk_bf16_f32 v55, v30, v31
    s_waitcnt lgkmcnt(0)
    v_mfma_f32_32x32x16_bf16 v[16:31], v[88:91], v[4:7], 0
    ds_add_u32 v112, v111 offset:36
    v_readfirstlane_b32 s42, v115
    s_nop 3
    s_cmp_ge_u32 s42, s36
    s_cbranch_scc1 ok_76
    s_mov_b32 s43, 0
rt_77:
    s_sleep 1
    ds_read_b32 v115, v112 offset:12
    s_waitcnt lgkmcnt(0)
    v_readfirstlane_b32 s42, v115
    s_add_u32 s43, s43, 1
    s_cmp_ge_u32 s43, 320000
    s_cbranch_scc1 ok_76
    s_cmp_lt_u32 s42, s36
    s_cbranch_scc1 rt_77
ok_76:
nf_75:
    v_exp_f32 v32, v32
    v_exp_f32 v33, v33
    v_exp_f32 v34, v34
    v_exp_f32 v35, v35
    v_cvt_pk_bf16_f32 v48, v32, v33
    v_cvt_pk_bf16_f32 v49, v34, v35
    v_mfma_f32_32x32x16_bf16 v[56:71], v[100:103], v[52:55], v[56:71]
    v_exp_f32 v36, v36
    v_exp_f32 v37, v37
    v_exp_f32 v38, v38
    v_exp_f32 v39, v39
    v_cvt_pk_bf16_f32 v50, v36, v37
    v_cvt_pk_bf16_f32 v51, v38, v39
    v_mfma_f32_32x32x8_bf16 v[16:31], v[92:93], v[8:9], v[16:31]
    v_exp_f32 v40, v40
    v_exp_f32 v41, v41
    v_exp_f32 v42, v42
    v_exp_f32 v43, v43
    v_cvt_pk_bf16_f32 v52, v40, v41
    v_cvt_pk_bf16_f32 v53, v42, v43
    v_mfma_f32_32x32x16_bf16 v[72:87], v[96:99], v[48:51], v[72:87]
    ds_read_b128 v[96:99], v106 offset:15360
    v_exp_f32 v44, v44
    v_exp_f32 v45, v45
    v_exp_f32 v46, v46
    v_exp_f32 v47, v47
    v_cvt_pk_bf16_f32 v54, v44, v45
    v_cvt_pk_bf16_f32 v55, v46, v47
    v_mfma_f32_32x32x16_bf16 v[32:47], v[88:91], v[10:13], 0
    ds_read_b128 v[88:91], v104 offset:18432
    ds_read_b32 v128, v151
    v_exp_f32 v16, v16
    v_exp_f32 v17, v17
    v_exp_f32 v18, v18
    v_exp_f32 v19, v19
    v_cvt_pk_bf16_f32 v48, v16, v17
    v_cvt_pk_bf16_f32 v49, v18, v19
    v_mfma_f32_32x32x16_bf16 v[72:87], v[100:103], v[52:55], v[72:87]
    ds_read_b128 v[100:103], v106 offset:16032
    v_exp_f32 v20, v20
    v_exp_f32 v21, v21
    v_exp_f32 v22, v22
    v_exp_f32 v23, v23
    v_cvt_pk_bf16_f32 v50, v20, v21
    v_cvt_pk_bf16_f32 v51, v22, v23
    v_mfma_f32_32x32x8_bf16 v[32:47], v[92:93], v[14:15], v[32:47]
    ds_read_b64 v[92:93], v105 offset:18432
    v_exp_f32 v24, v24
    v_exp_f32 v25, v25
    v_exp_f32 v26, v26
    v_exp_f32 v27, v27
    v_cvt_pk_bf16_f32 v52, v24, v25
    v_cvt_pk_bf16_f32 v53, v26, v27
    s_waitcnt lgkmcnt(4)
    v_mfma_f32_32x32x16_bf16 v[56:71], v[96:99], v[48:51], v[56:71]
    v_exp_f32 v28, v28
    v_exp_f32 v29, v29
    v_exp_f32 v30, v30
    v_exp_f32 v31, v31
    v_cvt_pk_bf16_f32 v54, v28, v29
    v_cvt_pk_bf16_f32 v55, v30, v31
    s_waitcnt lgkmcnt(0)
    v_mfma_f32_32x32x16_bf16 v[16:31], v[88:91], v[4:7], 0
    v_readfirstlane_b32 s42, v128
    s_nop 1
    s_cmp_gt_u32 s80, s42
    s_cbranch_scc1 pa_78
    s_setprio 2
    s_branch pb_79
pa_78:
    s_setprio 1
pb_79:
    v_exp_f32 v32, v32
    v_exp_f32 v33, v33
    v_exp_f32 v34, v34
    v_exp_f32 v35, v35
    v_cvt_pk_bf16_f32 v48, v32, v33
    v_cvt_pk_bf16_f32 v49, v34, v35
    v_mfma_f32_32x32x16_bf16 v[56:71], v[100:103], v[52:55], v[56:71]
    v_exp_f32 v36, v36
    v_exp_f32 v37, v37
    v_exp_f32 v38, v38
    v_exp_f32 v39, v39
    v_cvt_pk_bf16_f32 v50, v36, v37
    v_cvt_pk_bf16_f32 v51, v38, v39
    v_mfma_f32_32x32x8_bf16 v[16:31], v[92:93], v[8:9], v[16:31]
    v_exp_f32 v40, v40
    v_exp_f32 v41, v41
    v_exp_f32 v42, v42
    v_exp_f32 v43, v43
    v_cvt_pk_bf16_f32 v52, v40, v41
    v_cvt_pk_bf16_f32 v53, v42, v43
    v_mfma_f32_32x32x16_bf16 v[72:87], v[96:99], v[48:51], v[72:87]
    ds_read_b128 v[96:99], v106 offset:18432
    v_exp_f32 v44, v44
    v_exp_f32 v45, v45
    v_exp_f32 v46, v46
    v_exp_f32 v47, v47
    s_add_u32 s80, s80, 1
    v_mov_b32 v115, s80
    ds_write_b32 v150, v115
    v_cvt_pk_bf16_f32 v54, v44, v45
    v_cvt_pk_bf16_f32 v55, v46, v47
    v_mfma_f32_32x32x16_bf16 v[32:47], v[88:91], v[10:13], 0
    ds_read_b128 v[88:91], v104 offset:21504
    ds_read_b32 v115, v112 offset:0
    v_exp_f32 v16, v16
    v_exp_f32 v17, v17
    v_exp_f32 v18, v18
    v_exp_f32 v19, v19
    v_cvt_pk_bf16_f32 v48, v16, v17
    v_cvt_pk_bf16_f32 v49, v18, v19
    v_mfma_f32_32x32x16_bf16 v[72:87], v[100:103], v[52:55], v[72:87]
    ds_read_b128 v[100:103], v106 offset:19104
    v_exp_f32 v20, v20
    v_exp_f32 v21, v21
    v_exp_f32 v22, v22
    v_exp_f32 v23, v23
    v_cvt_pk_bf16_f32 v50, v20, v21
    v_cvt_pk_bf16_f32 v51, v22, v23
    v_mfma_f32_32x32x8_bf16 v[32:47], v[92:93], v[14:15], v[32:47]
    ds_read_b64 v[92:93], v105 offset:21504
    v_exp_f32 v24, v24
    v_exp_f32 v25, v25
    v_exp_f32 v26, v26
    v_exp_f32 v27, v27
    v_cvt_pk_bf16_f32 v52, v24, v25
    v_cvt_pk_bf16_f32 v53, v26, v27
    s_waitcnt lgkmcnt(4)
    v_mfma_f32_32x32x16_bf16 v[56:71], v[96:99], v[48:51], v[56:71]
    v_exp_f32 v28, v28
    v_exp_f32 v29, v29
    v_exp_f32 v30, v30
    v_exp_f32 v31, v31
    v_cvt_pk_bf16_f32 v54, v28, v29
    v_cvt_pk_bf16_f32 v55, v30, v31
    s_waitcnt lgkmcnt(0)
    v_mfma_f32_32x32x16_bf16 v[16:31], v[88:91], v[4:7], 0
    ds_add_u32 v112, v111 offset:40
    s_cmp_ge_u32 s34, 3
    s_cbranch_scc1 nf_80
    v_readfirstlane_b32 s42, v115
    s_nop 3
    s_cmp_ge_u32 s42, s37
    s_cbranch_scc1 ok_81
    s_mov_b32 s43, 0
rt_82:
    s_sleep 1
    ds_read_b32 v115, v112 offset:0
    s_waitcnt lgkmcnt(0)
    v_readfirstlane_b32 s42, v115
    s_add_u32 s43, s43, 1
    s_cmp_ge_u32 s43, 320000
    s_cbranch_scc1 ok_81
    s_cmp_lt_u32 s42, s37
    s_cbranch_scc1 rt_82
ok_81:
nf_80:
    v_exp_f32 v32, v32
    v_exp_f32 v33, v33
    v_exp_f32 v34, v34
    v_exp_f32 v35, v35
    v_cvt_pk_bf16_f32 v48, v32, v33
    v_cvt_pk_bf16_f32 v49, v34, v35
    v_mfma_f32_32x32x16_bf16 v[56:71], v[100:103], v[52:55], v[56:71]
    v_exp_f32 v36, v36
    v_exp_f32 v37, v37
    v_exp_f32 v38, v38
    v_exp_f32 v39, v39
    v_cvt_pk_bf16_f32 v50, v36, v37
    v_cvt_pk_bf16_f32 v51, v38, v39
    v_mfma_f32_32x32x8_bf16 v[16:31], v[92:93], v[8:9], v[16:31]
    v_exp_f32 v40, v40
    v_exp_f32 v41, v41
    v_exp_f32 v42, v42
    v_exp_f32 v43, v43
    v_cvt_pk_bf16_f32 v52, v40, v41
    v_cvt_pk_bf16_f32 v53, v42, v43
    v_mfma_f32_32x32x16_bf16 v[72:87], v[96:99], v[48:51], v[72:87]
    ds_read_b128 v[96:99], v106 offset:21504
    v_exp_f32 v44, v44
    v_exp_f32 v45, v45
    v_exp_f32 v46, v46
    v_exp_f32 v47, v47
    v_cvt_pk_bf16_f32 v54, v44, v45
    v_cvt_pk_bf16_f32 v55, v46, v47
    v_mfma_f32_32x32x16_bf16 v[32:47], v[88:91], v[10:13], 0
    ds_read_b128 v[88:91], v104 offset:0
    ds_read_b32 v128, v151
    v_exp_f32 v16, v16
    v_exp_f32 v17, v17
    v_exp_f32 v18, v18
    v_exp_f32 v19, v19
    v_cvt_pk_bf16_f32 v48, v16, v17
    v_cvt_pk_bf16_f32 v49, v18, v19
    v_mfma_f32_32x32x16_bf16 v[72:87], v[100:103], v[52:55], v[72:87]
    ds_read_b128 v[100:103], v106 offset:22176
    v_exp_f32 v20, v20
    v_exp_f32 v21, v21
    v_exp_f32 v22, v22
    v_exp_f32 v23, v23
    v_cvt_pk_bf16_f32 v50, v20, v21
    v_cvt_pk_bf16_f32 v51, v22, v23
    v_mfma_f32_32x32x8_bf16 v[32:47], v[92:93], v[14:15], v[32:47]
    ds_read_b64 v[92:93], v105 offset:0
    v_exp_f32 v24, v24
    v_exp_f32 v25, v25
    v_exp_f32 v26, v26
    v_exp_f32 v27, v27
    v_cvt_pk_bf16_f32 v52, v24, v25
    v_cvt_pk_bf16_f32 v53, v26, v27
    s_waitcnt lgkmcnt(4)
    v_mfma_f32_32x32x16_bf16 v[56:71], v[96:99], v[48:51], v[56:71]
    v_exp_f32 v28, v28
    v_exp_f32 v29, v29
    v_exp_f32 v30, v30
    v_exp_f32 v31, v31
    v_cvt_pk_bf16_f32 v54, v28, v29
    v_cvt_pk_bf16_f32 v55, v30, v31
    s_waitcnt lgkmcnt(0)
    v_mfma_f32_32x32x16_bf16 v[16:31], v[88:91], v[4:7], 0
    v_readfirstlane_b32 s42, v128
    s_nop 1
    s_cmp_gt_u32 s80, s42
    s_cbranch_scc1 pa_83
    s_setprio 2
    s_branch pb_84
pa_83:
    s_setprio 1
pb_84:
    v_exp_f32 v32, v32
    v_exp_f32 v33, v33
    v_exp_f32 v34, v34
    v_exp_f32 v35, v35
    v_cvt_pk_bf16_f32 v48, v32, v33
    v_cvt_pk_bf16_f32 v49, v34, v35
    v_mfma_f32_32x32x16_bf16 v[56:71], v[100:103], v[52:55], v[56:71]
    v_exp_f32 v36, v36
    v_exp_f32 v37, v37
    v_exp_f32 v38, v38
    v_exp_f32 v39, v39
    v_cvt_pk_bf16_f32 v50, v36, v37
    v_cvt_pk_bf16_f32 v51, v38, v39
    v_mfma_f32_32x32x8_bf16 v[16:31], v[92:93], v[8:9], v[16:31]
    v_exp_f32 v40, v40
    v_exp_f32 v41, v41
    v_exp_f32 v42, v42
    v_exp_f32 v43, v43
    v_cvt_pk_bf16_f32 v52, v40, v41
    v_cvt_pk_bf16_f32 v53, v42, v43
    v_mfma_f32_32x32x16_bf16 v[72:87], v[96:99], v[48:51], v[72:87]
    ds_read_b128 v[96:99], v106 offset:0
    v_exp_f32 v44, v44
    v_exp_f32 v45, v45
    v_exp_f32 v46, v46
    v_exp_f32 v47, v47
    s_add_u32 s80, s80, 1
    v_mov_b32 v115, s80
    ds_write_b32 v150, v115
    s_add_u32 s34, s34, 1
    s_add_u32 s36, s36, 1
    s_add_u32 s37, s37, 1
    s_cmp_lt_u32 s34, 4
    s_cbranch_scc1 f_attn
    s_mov_b32 s81, 0
    v_cvt_pk_bf16_f32 v54, v44, v45
    v_cvt_pk_bf16_f32 v55, v46, v47
    s_mul_i32 s28, s24, 24576
    s_mul_i32 s29, s23, 3072
    s_add_u32 s28, s28, s29
    v_add_u32 v164, s28, v110
    s_xor_b32 s30, s24, 1
    s_mul_i32 s30, s30, 24576
    s_add_u32 s29, s29, s30
    v_mfma_f32_32x32x16_bf16 v[72:87], v[100:103], v[52:55], v[72:87]
    v_add_u32 v165, s29, v110
    s_setprio 2
    s_waitcnt lgkmcnt(0)
    s_lshl_b32 s30, s24, 4
    s_add_u32 s30, s30, 162540
    v_mov_b32 v95, s30
    s_mov_b64 exec, 1
    ds_add_u32 v95, v111
    s_mov_b64 exec, -1
    s_mov_b32 s43, 0
lw_85:
    ds_read_b32 v3, v95
    s_waitcnt lgkmcnt(0)
    v_readfirstlane_b32 s42, v3
    s_nop 3
    s_cmp_ge_u32 s42, 4
    s_cbranch_scc1 lwd_86
    s_add_u32 s43, s43, 1
    s_cmp_lt_u32 s43, 320000
    s_cbranch_scc0 lwd_86
    s_branch lw_85
lwd_86:
    ds_write_b128 v164, v[72:75] offset:0
    ds_write_b128 v164, v[76:79] offset:1024
    ds_write_b128 v164, v[80:83] offset:2048
    s_lshl_b32 s28, s22, 2
    s_add_u32 s30, s28, 162560
    v_mov_b32 v95, s30
    s_mov_b64 exec, 1
    ds_add_u32 v95, v111
    s_mov_b64 exec, -1
    s_xor_b32 s28, s28, 16
    s_add_u32 s30, s28, 162560
    v_mov_b32 v2, s30
    s_mov_b32 s43, 0
lw_87:
    ds_read_b32 v3, v2
    s_waitcnt lgkmcnt(0)
    v_readfirstlane_b32 s42, v3
    s_nop 3
    s_cmp_ge_u32 s42, 1
    s_cbranch_scc1 lwd_88
    s_add_u32 s43, s43, 1
    s_cmp_lt_u32 s43, 320000
    s_cbranch_scc0 lwd_88
    s_branch lw_87
lwd_88:
    ds_read_b128 v[16:19], v165 offset:0
    ds_read_b128 v[20:23], v165 offset:1024
    ds_read_b128 v[24:27], v165 offset:2048
    s_waitcnt lgkmcnt(0)
    v_add_f32 v56, v56, v16
    v_add_f32 v57, v57, v17
    v_add_f32 v58, v58, v18
    v_add_f32 v59, v59, v19
    v_add_f32 v60, v60, v20
    v_add_f32 v61, v61, v21
    v_add_f32 v62, v62, v22
    v_add_f32 v63, v63, v23
    v_add_f32 v64, v64, v24
    v_add_f32 v65, v65, v25
    v_add_f32 v66, v66, v26
    v_add_f32 v67, v67, v27
f_norm:
    v_mov_b32 v40, v64
    v_mov_b32 v41, v64
    s_nop 1
    v_permlane32_swap_b32 v40, v41
    v_max3_f32 v42, abs(v56), abs(v57), abs(v58)
    v_max3_f32 v43, abs(v59), abs(v60), abs(v61)
    v_max3_f32 v42, v42, abs(v62), abs(v63)
    v_max3_f32 v43, v43, abs(v64), abs(v65)
    v_max3_f32 v42, v42, abs(v66), abs(v67)
    v_max_f32 v42, v42, v43
    s_mov_b32 s28, 0x21800000
    s_mov_b32 s29, 0x5d800000
    s_mov_b32 s30, 0x7e800000
    v_cmp_le_f32 s[40:41], s28, v41
    v_cmp_ge_f32 vcc, s29, v41
    s_and_b64 s[40:41], s[40:41], vcc
    v_cmp_gt_f32 vcc, s30, v42
    s_and_b64 s[40:41], s[40:41], vcc
    s_or_b32 s40, s40, s81
    s_or_b32 s41, s41, s81
    s_cmp_eq_u64 s[40:41], -1
    s_cbranch_scc0 f_fallback
    v_rcp_f32 v41, v41
    s_nop 0
    v_mul_f32 v56, v56, v41
    v_mul_f32 v57, v57, v41
    v_mul_f32 v58, v58, v41
    v_mul_f32 v59, v59, v41
    v_mul_f32 v60, v60, v41
    v_mul_f32 v61, v61, v41
    v_mul_f32 v62, v62, v41
    v_mul_f32 v63, v63, v41
    v_mul_f32 v64, v64, v41
    v_mul_f32 v65, v65, v41
    v_mul_f32 v66, v66, v41
    v_mul_f32 v67, v67, v41
    v_cvt_pk_bf16_f32 v104, v56, v57
    v_cvt_pk_bf16_f32 v105, v58, v59
    v_cvt_pk_bf16_f32 v106, v60, v61
    v_cvt_pk_bf16_f32 v107, v62, v63
    v_cvt_pk_bf16_f32 v108, v64, v65
    v_cvt_pk_bf16_f32 v109, v66, v67
    ds_write_b64 v129, v[104:105]
    ds_write_b64 v129, v[106:107] offset:16
    s_mov_b64 exec, 0xffffffff
    ds_write_b64 v129, v[108:109] offset:32
    s_mov_b64 exec, -1
    v_mov_b32 v95, 162544
    s_mov_b64 exec, 1
    ds_add_u32 v95, v111
    s_mov_b64 exec, -1
    s_mul_i32 s29, s20, 81920
    s_mul_i32 s30, s21, 2560
    s_add_u32 s29, s29, s30
    s_add_u32 s29, s29, 5505024
    v_mov_b32 v2, 162544
    s_mov_b32 s43, 0
lw_89:
    ds_read_b32 v3, v2
    s_waitcnt lgkmcnt(0)
    v_readfirstlane_b32 s42, v3
    s_nop 3
    s_cmp_ge_u32 s42, 8
    s_cbranch_scc1 lwd_90
    s_add_u32 s43, s43, 1
    s_cmp_lt_u32 s43, 320000
    s_cbranch_scc0 lwd_90
    s_branch lw_89
lwd_90:
    ds_read_b128 v[44:47], v130
    s_cmp_ge_u32 s22, 2
    s_cbranch_scc1 ifw_91
    ds_read_b128 v[48:51], v132
ifw_91:
    s_waitcnt lgkmcnt(0)
    buffer_store_dwordx4 v[44:47], v131, s[12:15], s29 offen sc1
    s_cmp_ge_u32 s22, 2
    s_cbranch_scc1 ifw_92
    buffer_store_dwordx4 v[48:51], v133, s[12:15], s29 offen sc1
ifw_92:
    v_mov_b32 v56, 0
    v_mov_b32 v57, 0
    v_mov_b32 v58, 0
    v_mov_b32 v59, 0
    v_mov_b32 v60, 0
    v_mov_b32 v61, 0
    v_mov_b32 v62, 0
    v_mov_b32 v63, 0
    v_mov_b32 v64, 0
    v_mov_b32 v65, 0
    v_mov_b32 v66, 0
    v_mov_b32 v67, 0
    v_mov_b32 v68, 0
    v_mov_b32 v69, 0
    v_mov_b32 v70, 0
    v_mov_b32 v71, 0
    v_mov_b32 v72, 0
    v_mov_b32 v73, 0
    v_mov_b32 v74, 0
    v_mov_b32 v75, 0
    s_mul_i32 s28, s20, 81920
    s_mul_i32 s29, s23, 20480
    s_add_u32 s28, s28, s29
    s_mul_i32 s29, s24, 10240
    s_add_u32 s28, s28, s29
    s_add_u32 s28, s28, 5505024
    s_waitcnt vmcnt(0)
    v_mov_b32 v95, 162396
    s_mov_b64 exec, 1
    ds_add_u32 v95, v111
    s_mov_b64 exec, -1
    v_mov_b32 v2, 162428
    s_mov_b32 s43, 0
lw_93:
    ds_read_b32 v3, v2
    s_waitcnt lgkmcnt(0)
    v_readfirstlane_b32 s42, v3
    s_nop 3
    s_cmp_ge_u32 s42, 3
    s_cbranch_scc1 lwd_94
    s_add_u32 s43, s43, 1
    s_cmp_lt_u32 s43, 320000
    s_cbranch_scc0 lwd_94
    s_sleep 1
    s_branch lw_93
lwd_94:
    ds_read_b64_tr_b16 v[76:77], v135 offset:0
    ds_read_b64_tr_b16 v[78:79], v135 offset:1280
    ds_read_b64_tr_b16 v[80:81], v135 offset:32
    ds_read_b64_tr_b16 v[82:83], v135 offset:1312
    ds_read_b64_tr_b16 v[84:85], v135 offset:64
    ds_read_b64_tr_b16 v[86:87], v135 offset:1344
    ds_read_b64_tr_b16 v[88:89], v135 offset:96
    ds_read_b64_tr_b16 v[90:91], v135 offset:1376
    ds_read_b64_tr_b16 v[92:93], v135 offset:128
    ds_read_b64_tr_b16 v[94:95], v135 offset:1408
    v_mov_b32 v2, 162400
    s_mov_b32 s43, 0
lw_95:
    ds_read_b32 v3, v2
    s_waitcnt lgkmcnt(0)
    v_readfirstlane_b32 s42, v3
    s_nop 3
    s_cmp_ge_u32 s42, 1
    s_cbranch_scc1 lwd_96
    s_add_u32 s43, s43, 1
    s_cmp_lt_u32 s43, 320000
    s_cbranch_scc0 lwd_96
    s_branch lw_95
lwd_96:
    buffer_load_dwordx4 v[16:19], v139, s[12:15], s28 offen offset:0 sc1
    buffer_load_dwordx4 v[20:23], v139, s[12:15], s28 offen offset:1024 sc1
    buffer_load_dwordx4 v[24:27], v139, s[12:15], s28 offen offset:2048 sc1
    buffer_load_dwordx4 v[28:31], v139, s[12:15], s28 offen offset:3072 sc1
    s_add_u32 s28, s28, 4096
    buffer_load_dwordx4 v[32:35], v139, s[12:15], s28 offen offset:0 sc1
    buffer_load_dwordx4 v[36:39], v139, s[12:15], s28 offen offset:1024 sc1
    buffer_load_dwordx4 v[40:43], v139, s[12:15], s28 offen offset:2048 sc1
    buffer_load_dwordx4 v[44:47], v139, s[12:15], s28 offen offset:3072 sc1
    s_add_u32 s28, s28, 4096
    buffer_load_dwordx4 v[48:51], v139, s[12:15], s28 offen offset:0 sc1
    buffer_load_dwordx4 v[52:55], v139, s[12:15], s28 offen offset:1024 sc1
    ds_read_b64_tr_b16 v[96:97], v135 offset:5120
    ds_read_b64_tr_b16 v[98:99], v135 offset:6400
    ds_read_b64_tr_b16 v[100:101], v135 offset:5152
    ds_read_b64_tr_b16 v[102:103], v135 offset:6432
    ds_read_b64_tr_b16 v[104:105], v135 offset:5184
    ds_read_b64_tr_b16 v[106:107], v135 offset:6464
    ds_read_b64_tr_b16 v[108:109], v135 offset:5216
    ds_read_b64_tr_b16 v[110:111], v135 offset:6496
    ds_read_b64_tr_b16 v[112:113], v135 offset:5248
    ds_read_b64_tr_b16 v[114:115], v135 offset:6528
    s_waitcnt lgkmcnt(10) vmcnt(9)
    v_mfma_f32_16x16x32_bf16 v[56:59], v[76:79], v[16:19], v[56:59]
    v_mfma_f32_16x16x32_bf16 v[60:63], v[80:83], v[16:19], v[60:63]
    v_mfma_f32_16x16x32_bf16 v[64:67], v[84:87], v[16:19], v[64:67]
    v_mfma_f32_16x16x32_bf16 v[68:71], v[88:91], v[16:19], v[68:71]
    v_mfma_f32_16x16x32_bf16 v[72:75], v[92:95], v[16:19], v[72:75]
    ds_read_b64_tr_b16 v[76:77], v135 offset:10240
    ds_read_b64_tr_b16 v[78:79], v135 offset:11520
    ds_read_b64_tr_b16 v[80:81], v135 offset:10272
    ds_read_b64_tr_b16 v[82:83], v135 offset:11552
    ds_read_b64_tr_b16 v[84:85], v135 offset:10304
    ds_read_b64_tr_b16 v[86:87], v135 offset:11584
    ds_read_b64_tr_b16 v[88:89], v135 offset:10336
    ds_read_b64_tr_b16 v[90:91], v135 offset:11616
    ds_read_b64_tr_b16 v[92:93], v135 offset:10368
    ds_read_b64_tr_b16 v[94:95], v135 offset:11648
    s_waitcnt lgkmcnt(10) vmcnt(8)
    v_mfma_f32_16x16x32_bf16 v[56:59], v[96:99], v[20:23], v[56:59]
    v_mfma_f32_16x16x32_bf16 v[60:63], v[100:103], v[20:23], v[60:63]
    v_mfma_f32_16x16x32_bf16 v[64:67], v[104:107], v[20:23], v[64:67]
    v_mfma_f32_16x16x32_bf16 v[68:71], v[108:111], v[20:23], v[68:71]
    v_mfma_f32_16x16x32_bf16 v[72:75], v[112:115], v[20:23], v[72:75]
    ds_read_b64_tr_b16 v[96:97], v135 offset:15360
    ds_read_b64_tr_b16 v[98:99], v135 offset:16640
    ds_read_b64_tr_b16 v[100:101], v135 offset:15392
    ds_read_b64_tr_b16 v[102:103], v135 offset:16672
    ds_read_b64_tr_b16 v[104:105], v135 offset:15424
    ds_read_b64_tr_b16 v[106:107], v135 offset:16704
    ds_read_b64_tr_b16 v[108:109], v135 offset:15456
    ds_read_b64_tr_b16 v[110:111], v135 offset:16736
    ds_read_b64_tr_b16 v[112:113], v135 offset:15488
    ds_read_b64_tr_b16 v[114:115], v135 offset:16768
    s_waitcnt lgkmcnt(10) vmcnt(7)
    v_mfma_f32_16x16x32_bf16 v[56:59], v[76:79], v[24:27], v[56:59]
    v_mfma_f32_16x16x32_bf16 v[60:63], v[80:83], v[24:27], v[60:63]
    v_mfma_f32_16x16x32_bf16 v[64:67], v[84:87], v[24:27], v[64:67]
    v_mfma_f32_16x16x32_bf16 v[68:71], v[88:91], v[24:27], v[68:71]
    v_mfma_f32_16x16x32_bf16 v[72:75], v[92:95], v[24:27], v[72:75]
    ds_read_b64_tr_b16 v[76:77], v135 offset:20480
    ds_read_b64_tr_b16 v[78:79], v135 offset:21760
    ds_read_b64_tr_b16 v[80:81], v135 offset:20512
    ds_read_b64_tr_b16 v[82:83], v135 offset:21792
    ds_read_b64_tr_b16 v[84:85], v135 offset:20544
    ds_read_b64_tr_b16 v[86:87], v135 offset:21824
    ds_read_b64_tr_b16 v[88:89], v135 offset:20576
    ds_read_b64_tr_b16 v[90:91], v135 offset:21856
    ds_read_b64_tr_b16 v[92:93], v135 offset:20608
    ds_read_b64_tr_b16 v[94:95], v135 offset:21888
    s_waitcnt lgkmcnt(10) vmcnt(6)
    v_mfma_f32_16x16x32_bf16 v[56:59], v[96:99], v[28:31], v[56:59]
    v_mfma_f32_16x16x32_bf16 v[60:63], v[100:103], v[28:31], v[60:63]
    v_mfma_f32_16x16x32_bf16 v[64:67], v[104:107], v[28:31], v[64:67]
    v_mfma_f32_16x16x32_bf16 v[68:71], v[108:111], v[28:31], v[68:71]
    v_mfma_f32_16x16x32_bf16 v[72:75], v[112:115], v[28:31], v[72:75]
    ds_read_b64_tr_b16 v[96:97], v135 offset:25600
    ds_read_b64_tr_b16 v[98:99], v135 offset:26880
    ds_read_b64_tr_b16 v[100:101], v135 offset:25632
    ds_read_b64_tr_b16 v[102:103], v135 offset:26912
    ds_read_b64_tr_b16 v[104:105], v135 offset:25664
    ds_read_b64_tr_b16 v[106:107], v135 offset:26944
    ds_read_b64_tr_b16 v[108:109], v135 offset:25696
    ds_read_b64_tr_b16 v[110:111], v135 offset:26976
    ds_read_b64_tr_b16 v[112:113], v135 offset:25728
    ds_read_b64_tr_b16 v[114:115], v135 offset:27008
    s_waitcnt lgkmcnt(10) vmcnt(5)
    v_mfma_f32_16x16x32_bf16 v[56:59], v[76:79], v[32:35], v[56:59]
    v_mfma_f32_16x16x32_bf16 v[60:63], v[80:83], v[32:35], v[60:63]
    v_mfma_f32_16x16x32_bf16 v[64:67], v[84:87], v[32:35], v[64:67]
    v_mfma_f32_16x16x32_bf16 v[68:71], v[88:91], v[32:35], v[68:71]
    v_mfma_f32_16x16x32_bf16 v[72:75], v[92:95], v[32:35], v[72:75]
    ds_read_b64_tr_b16 v[76:77], v135 offset:30720
    ds_read_b64_tr_b16 v[78:79], v135 offset:32000
    ds_read_b64_tr_b16 v[80:81], v135 offset:30752
    ds_read_b64_tr_b16 v[82:83], v135 offset:32032
    ds_read_b64_tr_b16 v[84:85], v135 offset:30784
    ds_read_b64_tr_b16 v[86:87], v135 offset:32064
    ds_read_b64_tr_b16 v[88:89], v135 offset:30816
    ds_read_b64_tr_b16 v[90:91], v135 offset:32096
    ds_read_b64_tr_b16 v[92:93], v135 offset:30848
    ds_read_b64_tr_b16 v[94:95], v135 offset:32128
    s_waitcnt lgkmcnt(10) vmcnt(4)
    v_mfma_f32_16x16x32_bf16 v[56:59], v[96:99], v[36:39], v[56:59]
    v_mfma_f32_16x16x32_bf16 v[60:63], v[100:103], v[36:39], v[60:63]
    v_mfma_f32_16x16x32_bf16 v[64:67], v[104:107], v[36:39], v[64:67]
    v_mfma_f32_16x16x32_bf16 v[68:71], v[108:111], v[36:39], v[68:71]
    v_mfma_f32_16x16x32_bf16 v[72:75], v[112:115], v[36:39], v[72:75]
    ds_read_b64_tr_b16 v[96:97], v135 offset:35840
    ds_read_b64_tr_b16 v[98:99], v135 offset:37120
    ds_read_b64_tr_b16 v[100:101], v135 offset:35872
    ds_read_b64_tr_b16 v[102:103], v135 offset:37152
    ds_read_b64_tr_b16 v[104:105], v135 offset:35904
    ds_read_b64_tr_b16 v[106:107], v135 offset:37184
    ds_read_b64_tr_b16 v[108:109], v135 offset:35936
    ds_read_b64_tr_b16 v[110:111], v135 offset:37216
    ds_read_b64_tr_b16 v[112:113], v135 offset:35968
    ds_read_b64_tr_b16 v[114:115], v135 offset:37248
    s_waitcnt lgkmcnt(10) vmcnt(3)
    v_mfma_f32_16x16x32_bf16 v[56:59], v[76:79], v[40:43], v[56:59]
    v_mfma_f32_16x16x32_bf16 v[60:63], v[80:83], v[40:43], v[60:63]
    v_mfma_f32_16x16x32_bf16 v[64:67], v[84:87], v[40:43], v[64:67]
    v_mfma_f32_16x16x32_bf16 v[68:71], v[88:91], v[40:43], v[68:71]
    v_mfma_f32_16x16x32_bf16 v[72:75], v[92:95], v[40:43], v[72:75]
    ds_read_b64_tr_b16 v[76:77], v135 offset:40960
    ds_read_b64_tr_b16 v[78:79], v135 offset:42240
    ds_read_b64_tr_b16 v[80:81], v135 offset:40992
    ds_read_b64_tr_b16 v[82:83], v135 offset:42272
    ds_read_b64_tr_b16 v[84:85], v135 offset:41024
    ds_read_b64_tr_b16 v[86:87], v135 offset:42304
    ds_read_b64_tr_b16 v[88:89], v135 offset:41056
    ds_read_b64_tr_b16 v[90:91], v135 offset:42336
    ds_read_b64_tr_b16 v[92:93], v135 offset:41088
    ds_read_b64_tr_b16 v[94:95], v135 offset:42368
    s_waitcnt lgkmcnt(10) vmcnt(2)
    v_mfma_f32_16x16x32_bf16 v[56:59], v[96:99], v[44:47], v[56:59]
    v_mfma_f32_16x16x32_bf16 v[60:63], v[100:103], v[44:47], v[60:63]
    v_mfma_f32_16x16x32_bf16 v[64:67], v[104:107], v[44:47], v[64:67]
    v_mfma_f32_16x16x32_bf16 v[68:71], v[108:111], v[44:47], v[68:71]
    v_mfma_f32_16x16x32_bf16 v[72:75], v[112:115], v[44:47], v[72:75]
    ds_read_b64_tr_b16 v[96:97], v135 offset:46080
    ds_read_b64_tr_b16 v[98:99], v135 offset:47360
    ds_read_b64_tr_b16 v[100:101], v135 offset:46112
    ds_read_b64_tr_b16 v[102:103], v135 offset:47392
    ds_read_b64_tr_b16 v[104:105], v135 offset:46144
    ds_read_b64_tr_b16 v[106:107], v135 offset:47424
    ds_read_b64_tr_b16 v[108:109], v135 offset:46176
    ds_read_b64_tr_b16 v[110:111], v135 offset:47456
    ds_read_b64_tr_b16 v[112:113], v135 offset:46208
    ds_read_b64_tr_b16 v[114:115], v135 offset:47488
    s_waitcnt lgkmcnt(10) vmcnt(1)
    v_mfma_f32_16x16x32_bf16 v[56:59], v[76:79], v[48:51], v[56:59]
    v_mfma_f32_16x16x32_bf16 v[60:63], v[80:83], v[48:51], v[60:63]
    v_mfma_f32_16x16x32_bf16 v[64:67], v[84:87], v[48:51], v[64:67]
    v_mfma_f32_16x16x32_bf16 v[68:71], v[88:91], v[48:51], v[68:71]
    v_mfma_f32_16x16x32_bf16 v[72:75], v[92:95], v[48:51], v[72:75]
    s_waitcnt lgkmcnt(0) vmcnt(0)
    v_mfma_f32_16x16x32_bf16 v[56:59], v[96:99], v[52:55], v[56:59]
    v_mfma_f32_16x16x32_bf16 v[60:63], v[100:103], v[52:55], v[60:63]
    v_mfma_f32_16x16x32_bf16 v[64:67], v[104:107], v[52:55], v[64:67]
    v_mfma_f32_16x16x32_bf16 v[68:71], v[108:111], v[52:55], v[68:71]
    v_mfma_f32_16x16x32_bf16 v[72:75], v[112:115], v[52:55], v[72:75]
    s_xor_b32 s29, s22, 4
    s_mul_i32 s29, s29, 3072
    s_add_u32 s29, s29, 0
    v_add_u32 v165, s29, v139
    v_mov_b32 v2, 162528
    s_mov_b32 s43, 0
lw_97:
    ds_read_b32 v3, v2
    s_waitcnt lgkmcnt(0)
    v_readfirstlane_b32 s42, v3
    s_nop 3
    s_cmp_ge_u32 s42, 2
    s_cbranch_scc1 lwd_98
    s_add_u32 s43, s43, 1
    s_cmp_lt_u32 s43, 320000
    s_cbranch_scc0 lwd_98
    s_branch lw_97
lwd_98:
    s_cmp_ge_u32 s22, 4
    s_cbranch_scc1 f_finb
    ds_read_b64_tr_b16 v[16:17], v136 offset:0
    ds_read_b64_tr_b16 v[18:19], v136 offset:2048
    ds_read_b64_tr_b16 v[20:21], v136 offset:4096
    ds_read_b32 v30, v137
    s_nop 3
    ds_write_b128 v138, v[68:71] offset:0
    ds_write_b128 v138, v[72:75] offset:1024
    s_lshl_b32 s28, s22, 2
    s_add_u32 s30, s28, 162592
    v_mov_b32 v2, s30
    v_mov_b32 v3, 1
    s_mov_b64 exec, 1
    ds_add_u32 v2, v3
    s_mov_b64 exec, -1
    s_waitcnt lgkmcnt(0)
    v_lshlrev_b32 v32, 16, v16
    v_and_b32 v33, 0xffff0000, v16
    v_lshlrev_b32 v52, 16, v140
    v_and_b32 v53, 0xffff0000, v140
    v_mul_f32 v52, v52, v30
    v_mul_f32 v53, v53, v30
    v_mul_f32 v32, v32, v52
    v_mul_f32 v33, v33, v53
    v_lshlrev_b32 v34, 16, v17
    v_and_b32 v35, 0xffff0000, v17
    v_lshlrev_b32 v52, 16, v141
    v_and_b32 v53, 0xffff0000, v141
    v_mul_f32 v52, v52, v30
    v_mul_f32 v53, v53, v30
    v_mul_f32 v34, v34, v52
    v_mul_f32 v35, v35, v53
    v_lshlrev_b32 v36, 16, v18
    v_and_b32 v37, 0xffff0000, v18
    v_lshlrev_b32 v52, 16, v142
    v_and_b32 v53, 0xffff0000, v142
    v_mul_f32 v52, v52, v30
    v_mul_f32 v53, v53, v30
    v_mul_f32 v36, v36, v52
    v_mul_f32 v37, v37, v53
    v_lshlrev_b32 v38, 16, v19
    v_and_b32 v39, 0xffff0000, v19
    v_lshlrev_b32 v52, 16, v143
    v_and_b32 v53, 0xffff0000, v143
    v_mul_f32 v52, v52, v30
    v_mul_f32 v53, v53, v30
    v_mul_f32 v38, v38, v52
    v_mul_f32 v39, v39, v53
    v_lshlrev_b32 v40, 16, v20
    v_and_b32 v41, 0xffff0000, v20
    v_lshlrev_b32 v52, 16, v144
    v_and_b32 v53, 0xffff0000, v144
    v_mul_f32 v52, v52, v30
    v_mul_f32 v53, v53, v30
    v_mul_f32 v40, v40, v52
    v_mul_f32 v41, v41, v53
    v_lshlrev_b32 v42, 16, v21
    v_and_b32 v43, 0xffff0000, v21
    v_lshlrev_b32 v52, 16, v145
    v_and_b32 v53, 0xffff0000, v145
    v_mul_f32 v52, v52, v30
    v_mul_f32 v53, v53, v30
    v_mul_f32 v42, v42, v52
    v_mul_f32 v43, v43, v53
    v_sub_f32 v31, 1.0, v30
    s_xor_b32 s28, s28, 16
    s_add_u32 s30, s28, 162592
    v_mov_b32 v2, s30
    s_mov_b32 s43, 0
lw_99:
    ds_read_b32 v3, v2
    s_waitcnt lgkmcnt(0)
    v_readfirstlane_b32 s42, v3
    s_nop 3
    s_cmp_ge_u32 s42, 1
    s_cbranch_scc1 lwd_100
    s_add_u32 s43, s43, 1
    s_cmp_lt_u32 s43, 320000
    s_cbranch_scc0 lwd_100
    s_branch lw_99
lwd_100:
    ds_read_b128 v[76:79], v165 offset:0
    ds_read_b128 v[80:83], v165 offset:1024
    ds_read_b128 v[84:87], v165 offset:2048
    s_waitcnt lgkmcnt(2)
    v_add_f32 v56, v56, v76
    v_add_f32 v57, v57, v77
    v_add_f32 v58, v58, v78
    v_add_f32 v59, v59, v79
    v_fmac_f32 v32, v56, v31
    v_fmac_f32 v33, v57, v31
    v_fmac_f32 v34, v58, v31
    v_fmac_f32 v35, v59, v31
    v_cvt_pk_bf16_f32 v100, v32, v33
    v_cvt_pk_bf16_f32 v101, v34, v35
    buffer_store_dwordx2 v[100:101], v134, s[68:71], 0 offen offset:0
    s_waitcnt lgkmcnt(1)
    v_add_f32 v60, v60, v80
    v_add_f32 v61, v61, v81
    v_add_f32 v62, v62, v82
    v_add_f32 v63, v63, v83
    v_fmac_f32 v36, v60, v31
    v_fmac_f32 v37, v61, v31
    v_fmac_f32 v38, v62, v31
    v_fmac_f32 v39, v63, v31
    v_cvt_pk_bf16_f32 v102, v36, v37
    v_cvt_pk_bf16_f32 v103, v38, v39
    buffer_store_dwordx2 v[102:103], v134, s[68:71], 0 offen offset:32
    s_waitcnt lgkmcnt(0)
    v_add_f32 v64, v64, v84
    v_add_f32 v65, v65, v85
    v_add_f32 v66, v66, v86
    v_add_f32 v67, v67, v87
    v_fmac_f32 v40, v64, v31
    v_fmac_f32 v41, v65, v31
    v_fmac_f32 v42, v66, v31
    v_fmac_f32 v43, v67, v31
    v_cvt_pk_bf16_f32 v104, v40, v41
    v_cvt_pk_bf16_f32 v105, v42, v43
    buffer_store_dwordx2 v[104:105], v134, s[68:71], 0 offen offset:64
    s_branch f_fin
f_finb:
    ds_read_b64_tr_b16 v[22:23], v136 offset:6144
    ds_read_b64_tr_b16 v[24:25], v136 offset:8192
    ds_read_b32 v30, v137
    s_nop 3
    ds_write_b128 v138, v[56:59] offset:0
    ds_write_b128 v138, v[60:63] offset:1024
    ds_write_b128 v138, v[64:67] offset:2048
    s_lshl_b32 s28, s22, 2
    s_add_u32 s30, s28, 162592
    v_mov_b32 v2, s30
    v_mov_b32 v3, 1
    s_mov_b64 exec, 1
    ds_add_u32 v2, v3
    s_mov_b64 exec, -1
    s_waitcnt lgkmcnt(0)
    v_lshlrev_b32 v44, 16, v22
    v_and_b32 v45, 0xffff0000, v22
    v_lshlrev_b32 v52, 16, v146
    v_and_b32 v53, 0xffff0000, v146
    v_mul_f32 v52, v52, v30
    v_mul_f32 v53, v53, v30
    v_mul_f32 v44, v44, v52
    v_mul_f32 v45, v45, v53
    v_lshlrev_b32 v46, 16, v23
    v_and_b32 v47, 0xffff0000, v23
    v_lshlrev_b32 v52, 16, v147
    v_and_b32 v53, 0xffff0000, v147
    v_mul_f32 v52, v52, v30
    v_mul_f32 v53, v53, v30
    v_mul_f32 v46, v46, v52
    v_mul_f32 v47, v47, v53
    v_lshlrev_b32 v48, 16, v24
    v_and_b32 v49, 0xffff0000, v24
    v_lshlrev_b32 v52, 16, v148
    v_and_b32 v53, 0xffff0000, v148
    v_mul_f32 v52, v52, v30
    v_mul_f32 v53, v53, v30
    v_mul_f32 v48, v48, v52
    v_mul_f32 v49, v49, v53
    v_lshlrev_b32 v50, 16, v25
    v_and_b32 v51, 0xffff0000, v25
    v_lshlrev_b32 v52, 16, v149
    v_and_b32 v53, 0xffff0000, v149
    v_mul_f32 v52, v52, v30
    v_mul_f32 v53, v53, v30
    v_mul_f32 v50, v50, v52
    v_mul_f32 v51, v51, v53
    v_sub_f32 v31, 1.0, v30
    s_xor_b32 s28, s28, 16
    s_add_u32 s30, s28, 162592
    v_mov_b32 v2, s30
    s_mov_b32 s43, 0
lw_101:
    ds_read_b32 v3, v2
    s_waitcnt lgkmcnt(0)
    v_readfirstlane_b32 s42, v3
    s_nop 3
    s_cmp_ge_u32 s42, 1
    s_cbranch_scc1 lwd_102
    s_add_u32 s43, s43, 1
    s_cmp_lt_u32 s43, 320000
    s_cbranch_scc0 lwd_102
    s_branch lw_101
lwd_102:
    ds_read_b128 v[76:79], v165 offset:0
    ds_read_b128 v[80:83], v165 offset:1024
    s_waitcnt lgkmcnt(1)
    v_add_f32 v68, v68, v76
    v_add_f32 v69, v69, v77
    v_add_f32 v70, v70, v78
    v_add_f32 v71, v71, v79
    v_fmac_f32 v44, v68, v31
    v_fmac_f32 v45, v69, v31
    v_fmac_f32 v46, v70, v31
    v_fmac_f32 v47, v71, v31
    v_cvt_pk_bf16_f32 v106, v44, v45
    v_cvt_pk_bf16_f32 v107, v46, v47
    buffer_store_dwordx2 v[106:107], v134, s[68:71], 0 offen offset:96
    s_waitcnt lgkmcnt(0)
    v_add_f32 v72, v72, v80
    v_add_f32 v73, v73, v81
    v_add_f32 v74, v74, v82
    v_add_f32 v75, v75, v83
    v_fmac_f32 v48, v72, v31
    v_fmac_f32 v49, v73, v31
    v_fmac_f32 v50, v74, v31
    v_fmac_f32 v51, v75, v31
    v_cvt_pk_bf16_f32 v108, v48, v49
    v_cvt_pk_bf16_f32 v109, v50, v51
    buffer_store_dwordx2 v[108:109], v134, s[68:71], 0 offen offset:128
    s_branch f_fin
f_fallback:
    v_lshlrev_b32 v44, 4, v1
    v_and_b32 v2, 31, v1
    v_lshlrev_b32 v3, 3, v2
    v_add_u32 v3, 1024, v3
    v_mov_b32 v45, 1280
    v_cmp_gt_u32 vcc, 32, v1
    v_min_u32 v47, 20, v2
    s_nop 0
    v_cndmask_b32 v45, v45, v3, vcc
    v_lshlrev_b32 v47, 4, v47
    v_lshrrev_b32 v46, 5, v1
    v_mul_u32_u24 v46, 336, v46
    v_add_u32 v46, v46, v47
    v_add_u32 v46, 1296, v46
    v_mov_b32 v47, 0xff800000
    s_mov_b32 s28, 0
fb1_103:
    buffer_load_dwordx4 v[88:91], v44, s[12:15], s28 offen sc1
    buffer_load_dwordx2 v[92:93], v45, s[12:15], s28 offen sc1
    s_waitcnt vmcnt(0)
    v_mfma_f32_32x32x16_bf16 v[16:31], v[88:91], v[4:7], 0
    v_mfma_f32_32x32x8_bf16 v[16:31], v[92:93], v[8:9], v[16:31]
    s_nop 15
    s_nop 3
    v_max3_f32 v47, v47, v16, v17
    v_max3_f32 v47, v47, v18, v19
    v_max3_f32 v47, v47, v20, v21
    v_max3_f32 v47, v47, v22, v23
    v_max3_f32 v47, v47, v24, v25
    v_max3_f32 v47, v47, v26, v27
    v_max3_f32 v47, v47, v28, v29
    v_max3_f32 v47, v47, v30, v31
    s_add_u32 s28, s28, 3072
    s_cmp_lt_u32 s28, 196608
    s_cbranch_scc1 fb1_103
    v_mov_b32 v2, v47
    v_mov_b32 v3, v47
    s_nop 1
    v_permlane32_swap_b32 v2, v3
    s_nop 1
    v_max3_f32 v47, v47, v2, v3
    v_sub_f32 v2, 0, v47
    v_cvt_pk_bf16_f32 v3, v2, v2
    v_and_b32 v42, 0xffff0000, v3
    v_sub_f32 v2, v2, v42
    v_cvt_pk_bf16_f32 v43, v2, v2
    v_and_b32 v42, 0xffff0000, v43
    v_sub_f32 v2, v2, v42
    v_cvt_pk_bf16_f32 v2, v2, v2
    v_and_b32 v3, 0xffff, v3
    v_or_b32 v3, v3, v42
    v_and_b32 v2, 0xffff, v2
    v_cmp_gt_u32 vcc, 32, v1
    s_nop 1
    v_cndmask_b32 v8, v3, v8, vcc
    v_cndmask_b32 v9, v2, v9, vcc
    v_mov_b32 v56, 0
    v_mov_b32 v57, 0
    v_mov_b32 v58, 0
    v_mov_b32 v59, 0
    v_mov_b32 v60, 0
    v_mov_b32 v61, 0
    v_mov_b32 v62, 0
    v_mov_b32 v63, 0
    v_mov_b32 v64, 0
    v_mov_b32 v65, 0
    v_mov_b32 v66, 0
    v_mov_b32 v67, 0
    v_mov_b32 v68, 0
    v_mov_b32 v69, 0
    v_mov_b32 v70, 0
    v_mov_b32 v71, 0
    s_mov_b32 s28, 0
fb2_104:
    buffer_load_dwordx4 v[88:91], v44, s[12:15], s28 offen sc1
    buffer_load_dwordx2 v[92:93], v45, s[12:15], s28 offen sc1
    buffer_load_dwordx4 v[96:99], v46, s[12:15], s28 offen sc1
    buffer_load_dwordx4 v[100:103], v46, s[12:15], s28 offen offset:672 sc1
    s_waitcnt vmcnt(0)
    v_mfma_f32_32x32x16_bf16 v[16:31], v[88:91], v[4:7], 0
    v_mfma_f32_32x32x8_bf16 v[16:31], v[92:93], v[8:9], v[16:31]
    s_nop 15
    s_nop 3
    v_exp_f32 v16, v16
    v_exp_f32 v17, v17
    v_exp_f32 v18, v18
    v_exp_f32 v19, v19
    v_exp_f32 v20, v20
    v_exp_f32 v21, v21
    v_exp_f32 v22, v22
    v_exp_f32 v23, v23
    v_exp_f32 v24, v24
    v_exp_f32 v25, v25
    v_exp_f32 v26, v26
    v_exp_f32 v27, v27
    v_exp_f32 v28, v28
    v_exp_f32 v29, v29
    v_exp_f32 v30, v30
    v_exp_f32 v31, v31
    s_nop 0
    v_cvt_pk_bf16_f32 v48, v16, v17
    v_cvt_pk_bf16_f32 v49, v18, v19
    v_cvt_pk_bf16_f32 v50, v20, v21
    v_cvt_pk_bf16_f32 v51, v22, v23
    v_cvt_pk_bf16_f32 v52, v24, v25
    v_cvt_pk_bf16_f32 v53, v26, v27
    v_cvt_pk_bf16_f32 v54, v28, v29
    v_cvt_pk_bf16_f32 v55, v30, v31
    s_nop 1
    v_mfma_f32_32x32x16_bf16 v[56:71], v[96:99], v[48:51], v[56:71]
    v_mfma_f32_32x32x16_bf16 v[56:71], v[100:103], v[52:55], v[56:71]
    s_add_u32 s28, s28, 3072
    s_cmp_lt_u32 s28, 196608
    s_cbranch_scc1 fb2_104
    s_nop 15
    s_mov_b32 s81, -1
    s_branch f_norm
f_pstart:
    s_setprio 3
    v_mov_b32 v4, 0
    s_cmp_lg_u32 s2, 0
    s_cbranch_scc1 ifw_106
    s_memrealtime s[28:29]
    s_waitcnt lgkmcnt(0)
    s_or_b32 s28, s28, 1
    v_mov_b32 v5, s28
    s_mov_b64 exec, 1
    buffer_store_dword v5, v4, s[72:75], 0 offen sc1
    s_mov_b64 exec, -1
ifw_106:
    buffer_load_dword v20, v4, s[72:75], 0 offen sc1
    v_lshlrev_b32 v6, 21, v1
    s_mov_b64 exec, 0xf
    buffer_load_dword v8, v6, s[12:15], 0 offen offset:2048
    s_mov_b64 exec, 0x3
    buffer_load_dword v9, v6, s[16:19], 0 offen
    buffer_load_dword v10, v6, s[68:71], 0 offen
    s_mov_b64 exec, 0x1
    buffer_load_dword v11, v6, s[64:67], 0 offen
    s_mov_b64 exec, -1
    v_lshlrev_b32 v5, 2, v1
    v_add_u32 v7, 162304, v5
    ds_write_b32 v7, v4
    ds_write_b32 v7, v4 offset:256
    s_mov_b64 exec, -1
    s_waitcnt lgkmcnt(0)
    s_barrier
    v_mov_b32 v2, 162412
    s_mov_b32 s43, 0
lw_107:
    ds_read_b32 v3, v2
    s_waitcnt lgkmcnt(0)
    v_readfirstlane_b32 s42, v3
    s_nop 3
    s_cmp_ge_u32 s42, 4
    s_cbranch_scc1 lwd_108
    s_add_u32 s43, s43, 1
    s_cmp_lt_u32 s43, 320000
    s_cbranch_scc0 lwd_108
    s_branch lw_107
lwd_108:
    v_lshlrev_b32 v2, 4, v1
    v_add_u32 v3, 131552, v2
    ds_read_b128 v[16:19], v3 offset:0
    ds_read_b128 v[20:23], v3 offset:1024
    ds_read_b128 v[24:27], v3 offset:6656
    ds_read_b128 v[28:31], v3 offset:7680
    ds_read_b128 v[32:35], v3 offset:13312
    ds_read_b128 v[36:39], v3 offset:14336
    ds_read_b128 v[40:43], v3 offset:19968
    ds_read_b128 v[44:47], v3 offset:20992
    s_lshl_b32 s28, s20, 1
    s_bfe_u32 s29, s21, 0x10001
    s_add_u32 s28, s28, s29
    s_mul_i32 s29, s28, 3072
    s_and_b32 s30, s21, 1
    s_waitcnt lgkmcnt(0)
    v_mov_b32 v12, 162532
    v_mov_b32 v13, 1
    ds_write_b32 v12, v13
    v_add_f32 v16, v16, v24
    v_add_f32 v17, v17, v25
    v_add_f32 v18, v18, v26
    v_add_f32 v19, v19, v27
    v_add_f32 v20, v20, v28
    v_add_f32 v21, v21, v29
    v_add_f32 v22, v22, v30
    v_add_f32 v23, v23, v31
    v_add_f32 v16, v16, v32
    v_add_f32 v17, v17, v33
    v_add_f32 v18, v18, v34
    v_add_f32 v19, v19, v35
    v_add_f32 v20, v20, v36
    v_add_f32 v21, v21, v37
    v_add_f32 v22, v22, v38
    v_add_f32 v23, v23, v39
    v_add_f32 v16, v16, v40
    v_add_f32 v17, v17, v41
    v_add_f32 v18, v18, v42
    v_add_f32 v19, v19, v43
    v_add_f32 v20, v20, v44
    v_add_f32 v21, v21, v45
    v_add_f32 v22, v22, v46
    v_add_f32 v23, v23, v47
    v_cvt_pk_bf16_f32 v48, v16, v17
    v_cvt_pk_bf16_f32 v49, v18, v19
    v_cvt_pk_bf16_f32 v52, v20, v21
    v_cvt_pk_bf16_f32 v53, v22, v23
    v_mov_b32 v54, v48
    v_mov_b32 v55, v49
    s_nop 1
    v_permlane32_swap_b32 v54, v50
    v_permlane32_swap_b32 v55, v51
    v_and_b32 v2, 15, v1
    v_bfe_u32 v3, v1, 4, 1
    s_cmp_ge_u32 s21, 4
    s_cbranch_scc1 stV_109
    s_lshl_b32 s31, s30, 4
    v_add_u32 v2, s31, v2
    v_lshlrev_b32 v3, 5, v3
    v_add_u32 v3, v3, v2
    v_lshlrev_b32 v3, 4, v3
    s_mov_b64 exec, 0xffffffff
    buffer_store_dwordx4 v[48:51], v3, s[12:15], s29 offen sc1
    s_mov_b64 exec, -1
    v_lshlrev_b32 v2, 3, v2
    v_add_u32 v2, 1024, v2
    v_mov_b32 v3, 1280
    v_mov_b32 v164, 0x3f803f80
    v_mov_b32 v165, 0x3f80
    v_cmp_eq_u32 vcc, 16, v1
    s_nop 1
    v_cndmask_b32 v2, v2, v3, vcc
    v_cndmask_b32 v52, v52, v164, vcc
    v_cndmask_b32 v53, v53, v165, vcc
    s_mov_b32 s41, 0xffff
    s_cmp_eq_u32 s30, 0
    s_cselect_b32 s40, 0x1ffff, s41
    s_mov_b32 s41, 0
    s_mov_b64 exec, s[40:41]
    buffer_store_dwordx2 v[52:53], v2, s[12:15], s29 offen sc1
    s_mov_b64 exec, -1
    s_branch pub_110
stV_109:
    s_mul_i32 s31, s30, 672
    s_add_u32 s31, s31, 1296
    v_mul_u32_u24 v3, 336, v3
    v_lshlrev_b32 v164, 4, v2
    v_add_u32 v3, v3, v164
    v_add_u32 v3, s31, v3
    s_mov_b64 exec, 0xffffffff
    buffer_store_dwordx4 v[48:51], v3, s[12:15], s29 offen sc1
    s_mov_b64 exec, -1
    v_mov_b32 v164, 0x3f803f80
    v_cmp_eq_u32 vcc, 4, v2
    s_nop 1
    v_cndmask_b32 v52, v52, v164, vcc
    v_cndmask_b32 v53, v53, v164, vcc
    v_mov_b32 v48, v52
    v_mov_b32 v49, v53
    s_nop 1
    v_permlane32_swap_b32 v48, v54
    v_permlane32_swap_b32 v49, v55
    s_mov_b32 s40, 0x001f001f
    s_mov_b32 s41, 0
    s_mov_b64 exec, s[40:41]
    s_nop 1
    buffer_store_dwordx4 v[52:55], v3, s[12:15], s29 offen offset:256 sc1
    s_mov_b64 exec, -1
pub_110:
    s_lshr_b32 s29, s28, 2
    s_lshl_b32 s29, s29, 7
    s_and_b32 s31, s28, 3
    s_lshl_b32 s31, s31, 2
    s_lshl_b32 s30, s30, 1
    s_add_u32 s31, s31, s30
    s_lshr_b32 s30, s21, 2
    s_add_u32 s31, s31, s30
    s_lshl_b32 s31, s31, 2
    s_add_u32 s34, s29, s31
    s_add_u32 s34, s34, 8126464
    s_mov_b32 s43, 0
poll_111:
    buffer_load_dword v5, v4, s[72:75], 0 offen sc1
    s_waitcnt vmcnt(0)
    v_readfirstlane_b32 s25, v5
    s_nop 3
    s_cmp_lg_u32 s25, 0
    s_cbranch_scc1 pdone_112
    s_add_u32 s43, s43, 1
    s_cmp_lt_u32 s43, 40000
    s_cbranch_scc0 pdone_112
    s_branch poll_111
pdone_112:
    v_lshlrev_b32 v2, 11, v1
    v_mov_b32 v3, s25
    s_mov_b64 exec, 0xff
    buffer_store_dword v3, v2, s[12:15], s34 offen sc1
    s_mov_b64 exec, -1
    v_mov_b32 v12, 162368
    v_mov_b32 v13, s25
    ds_write_b32 v12, v13
    v_mov_b32 v12, 162548
    v_mov_b32 v13, 1
    ds_write_b32 v12, v13
    s_lshl_b32 s39, s20, 6
    s_sub_u32 s33, s39, 3
    s_mul_i32 s38, s21, 160
    v_add_u32 v2, 0, v1
    v_mul_u32_u24 v3, 6554, v2
    v_lshrrev_b32 v3, 16, v3
    v_mul_u32_u24 v164, 10, v3
    v_sub_u32 v2, v2, v164
    v_lshrrev_b32 v164, 3, v3
    v_sub_u32 v2, v2, v164
    v_add_u32 v164, 10, v2
    v_min_u32 v2, v2, v164
    v_lshlrev_b32 v2, 4, v2
    v_add_u32 v3, s33, v3
    v_mul_lo_u32 v3, v3, s26
    v_add3_u32 v2, v2, v3, s38
    s_mov_b32 m0, 137472
    s_nop 0
    buffer_load_dwordx4 v2, s[44:47], 0 offen lds
    v_add_u32 v2, 64, v1
    v_mul_u32_u24 v3, 6554, v2
    v_lshrrev_b32 v3, 16, v3
    v_mul_u32_u24 v164, 10, v3
    v_sub_u32 v2, v2, v164
    v_lshrrev_b32 v164, 3, v3
    v_sub_u32 v2, v2, v164
    v_add_u32 v164, 10, v2
    v_min_u32 v2, v2, v164
    v_lshlrev_b32 v2, 4, v2
    v_add_u32 v3, s33, v3
    v_mul_lo_u32 v3, v3, s26
    v_add3_u32 v2, v2, v3, s38
    s_mov_b32 m0, 138496
    s_nop 0
    buffer_load_dwordx4 v2, s[44:47], 0 offen lds
    v_add_u32 v2, 128, v1
    v_mul_u32_u24 v3, 6554, v2
    v_lshrrev_b32 v3, 16, v3
    v_mul_u32_u24 v164, 10, v3
    v_sub_u32 v2, v2, v164
    v_lshrrev_b32 v164, 3, v3
    v_sub_u32 v2, v2, v164
    v_add_u32 v164, 10, v2
    v_min_u32 v2, v2, v164
    v_lshlrev_b32 v2, 4, v2
    v_add_u32 v3, s33, v3
    v_mul_lo_u32 v3, v3, s26
    v_add3_u32 v2, v2, v3, s38
    s_mov_b32 m0, 139520
    s_nop 0
    buffer_load_dwordx4 v2, s[44:47], 0 offen lds
    v_add_u32 v2, 192, v1
    v_mul_u32_u24 v3, 6554, v2
    v_lshrrev_b32 v3, 16, v3
    v_mul_u32_u24 v164, 10, v3
    v_sub_u32 v2, v2, v164
    v_lshrrev_b32 v164, 3, v3
    v_sub_u32 v2, v2, v164
    v_add_u32 v164, 10, v2
    v_min_u32 v2, v2, v164
    v_lshlrev_b32 v2, 4, v2
    v_add_u32 v3, s33, v3
    v_mul_lo_u32 v3, v3, s26
    v_add3_u32 v2, v2, v3, s38
    s_mov_b32 m0, 140544
    s_nop 0
    buffer_load_dwordx4 v2, s[44:47], 0 offen lds
    v_add_u32 v2, 256, v1
    v_mul_u32_u24 v3, 6554, v2
    v_lshrrev_b32 v3, 16, v3
    v_mul_u32_u24 v164, 10, v3
    v_sub_u32 v2, v2, v164
    v_lshrrev_b32 v164, 3, v3
    v_sub_u32 v2, v2, v164
    v_add_u32 v164, 10, v2
    v_min_u32 v2, v2, v164
    v_lshlrev_b32 v2, 4, v2
    v_add_u32 v3, s33, v3
    v_mul_lo_u32 v3, v3, s26
    v_add3_u32 v2, v2, v3, s38
    s_mov_b32 m0, 141568
    s_nop 0
    buffer_load_dwordx4 v2, s[44:47], 0 offen lds
    v_add_u32 v2, 320, v1
    v_mul_u32_u24 v3, 6554, v2
    v_lshrrev_b32 v3, 16, v3
    v_mul_u32_u24 v164, 10, v3
    v_sub_u32 v2, v2, v164
    v_lshrrev_b32 v164, 3, v3
    v_sub_u32 v2, v2, v164
    v_add_u32 v164, 10, v2
    v_min_u32 v2, v2, v164
    v_lshlrev_b32 v2, 4, v2
    v_add_u32 v3, s33, v3
    v_mul_lo_u32 v3, v3, s26
    v_add3_u32 v2, v2, v3, s38
    s_mov_b32 m0, 142592
    s_nop 0
    buffer_load_dwordx4 v2, s[44:47], 0 offen lds
    v_add_u32 v2, 384, v1
    v_mul_u32_u24 v3, 6554, v2
    v_lshrrev_b32 v3, 16, v3
    v_mul_u32_u24 v164, 10, v3
    v_sub_u32 v2, v2, v164
    v_lshrrev_b32 v164, 3, v3
    v_sub_u32 v2, v2, v164
    v_add_u32 v164, 10, v2
    v_min_u32 v2, v2, v164
    v_lshlrev_b32 v2, 4, v2
    v_add_u32 v3, s33, v3
    v_mul_lo_u32 v3, v3, s26
    v_add3_u32 v2, v2, v3, s38
    s_mov_b32 m0, 143616
    s_nop 0
    buffer_load_dwordx4 v2, s[44:47], 0 offen lds
    v_add_u32 v2, 448, v1
    v_mul_u32_u24 v3, 6554, v2
    v_lshrrev_b32 v3, 16, v3
    v_mul_u32_u24 v164, 10, v3
    v_sub_u32 v2, v2, v164
    v_lshrrev_b32 v164, 3, v3
    v_sub_u32 v2, v2, v164
    v_add_u32 v164, 10, v2
    v_min_u32 v2, v2, v164
    v_lshlrev_b32 v2, 4, v2
    v_add_u32 v3, s33, v3
    v_mul_lo_u32 v3, v3, s26
    v_add3_u32 v2, v2, v3, s38
    s_mov_b32 m0, 144640
    s_nop 0
    buffer_load_dwordx4 v2, s[44:47], 0 offen lds
    v_add_u32 v2, 512, v1
    v_mul_u32_u24 v3, 6554, v2
    v_lshrrev_b32 v3, 16, v3
    v_mul_u32_u24 v164, 10, v3
    v_sub_u32 v2, v2, v164
    v_lshrrev_b32 v164, 3, v3
    v_sub_u32 v2, v2, v164
    v_add_u32 v164, 10, v2
    v_min_u32 v2, v2, v164
    v_lshlrev_b32 v2, 4, v2
    v_add_u32 v3, s33, v3
    v_mul_lo_u32 v3, v3, s26
    v_add3_u32 v2, v2, v3, s38
    s_mov_b32 m0, 145664
    s_nop 0
    buffer_load_dwordx4 v2, s[44:47], 0 offen lds
    v_add_u32 v2, 576, v1
    v_mul_u32_u24 v3, 6554, v2
    v_lshrrev_b32 v3, 16, v3
    v_mul_u32_u24 v164, 10, v3
    v_sub_u32 v2, v2, v164
    v_lshrrev_b32 v164, 3, v3
    v_sub_u32 v2, v2, v164
    v_add_u32 v164, 10, v2
    v_min_u32 v2, v2, v164
    v_lshlrev_b32 v2, 4, v2
    v_add_u32 v3, s33, v3
    v_mul_lo_u32 v3, v3, s26
    v_add3_u32 v2, v2, v3, s38
    s_mov_b32 m0, 146688
    s_nop 0
    buffer_load_dwordx4 v2, s[44:47], 0 offen lds
    v_add_u32 v2, 640, v1
    v_mul_u32_u24 v3, 6554, v2
    v_lshrrev_b32 v3, 16, v3
    v_mul_u32_u24 v164, 10, v3
    v_sub_u32 v2, v2, v164
    v_lshrrev_b32 v164, 3, v3
    v_sub_u32 v2, v2, v164
    v_add_u32 v164, 10, v2
    v_min_u32 v2, v2, v164
    v_lshlrev_b32 v2, 4, v2
    v_add_u32 v3, s33, v3
    v_mul_lo_u32 v3, v3, s26
    v_add3_u32 v2, v2, v3, s38
    s_mov_b32 m0, 147712
    s_mov_b64 exec, 0x3fffffff
    buffer_load_dwordx4 v2, s[44:47], 0 offen lds
    s_mov_b64 exec, -1
    v_add_u32 v2, 0, v1
    v_mul_u32_u24 v3, 6554, v2
    v_lshrrev_b32 v3, 16, v3
    v_mul_u32_u24 v164, 10, v3
    v_sub_u32 v2, v2, v164
    v_lshrrev_b32 v164, 3, v3
    v_sub_u32 v2, v2, v164
    v_add_u32 v164, 10, v2
    v_min_u32 v2, v2, v164
    v_lshlrev_b32 v2, 4, v2
    v_add_u32 v3, s39, v3
    v_mul_lo_u32 v3, v3, s26
    v_add3_u32 v2, v2, v3, s38
    s_mov_b32 m0, 148192
    s_nop 0
    buffer_load_dwordx4 v2, s[48:51], 0 offen lds
    v_add_u32 v2, 64, v1
    v_mul_u32_u24 v3, 6554, v2
    v_lshrrev_b32 v3, 16, v3
    v_mul_u32_u24 v164, 10, v3
    v_sub_u32 v2, v2, v164
    v_lshrrev_b32 v164, 3, v3
    v_sub_u32 v2, v2, v164
    v_add_u32 v164, 10, v2
    v_min_u32 v2, v2, v164
    v_lshlrev_b32 v2, 4, v2
    v_add_u32 v3, s39, v3
    v_mul_lo_u32 v3, v3, s26
    v_add3_u32 v2, v2, v3, s38
    s_mov_b32 m0, 149216
    s_nop 0
    buffer_load_dwordx4 v2, s[48:51], 0 offen lds
    v_add_u32 v2, 128, v1
    v_mul_u32_u24 v3, 6554, v2
    v_lshrrev_b32 v3, 16, v3
    v_mul_u32_u24 v164, 10, v3
    v_sub_u32 v2, v2, v164
    v_lshrrev_b32 v164, 3, v3
    v_sub_u32 v2, v2, v164
    v_add_u32 v164, 10, v2
    v_min_u32 v2, v2, v164
    v_lshlrev_b32 v2, 4, v2
    v_add_u32 v3, s39, v3
    v_mul_lo_u32 v3, v3, s26
    v_add3_u32 v2, v2, v3, s38
    s_mov_b32 m0, 150240
    s_nop 0
    buffer_load_dwordx4 v2, s[48:51], 0 offen lds
    v_add_u32 v2, 192, v1
    v_mul_u32_u24 v3, 6554, v2
    v_lshrrev_b32 v3, 16, v3
    v_mul_u32_u24 v164, 10, v3
    v_sub_u32 v2, v2, v164
    v_lshrrev_b32 v164, 3, v3
    v_sub_u32 v2, v2, v164
    v_add_u32 v164, 10, v2
    v_min_u32 v2, v2, v164
    v_lshlrev_b32 v2, 4, v2
    v_add_u32 v3, s39, v3
    v_mul_lo_u32 v3, v3, s26
    v_add3_u32 v2, v2, v3, s38
    s_mov_b32 m0, 151264
    s_nop 0
    buffer_load_dwordx4 v2, s[48:51], 0 offen lds
    v_add_u32 v2, 256, v1
    v_mul_u32_u24 v3, 6554, v2
    v_lshrrev_b32 v3, 16, v3
    v_mul_u32_u24 v164, 10, v3
    v_sub_u32 v2, v2, v164
    v_lshrrev_b32 v164, 3, v3
    v_sub_u32 v2, v2, v164
    v_add_u32 v164, 10, v2
    v_min_u32 v2, v2, v164
    v_lshlrev_b32 v2, 4, v2
    v_add_u32 v3, s39, v3
    v_mul_lo_u32 v3, v3, s26
    v_add3_u32 v2, v2, v3, s38
    s_mov_b32 m0, 152288
    s_nop 0
    buffer_load_dwordx4 v2, s[48:51], 0 offen lds
    v_add_u32 v2, 320, v1
    v_mul_u32_u24 v3, 6554, v2
    v_lshrrev_b32 v3, 16, v3
    v_mul_u32_u24 v164, 10, v3
    v_sub_u32 v2, v2, v164
    v_lshrrev_b32 v164, 3, v3
    v_sub_u32 v2, v2, v164
    v_add_u32 v164, 10, v2
    v_min_u32 v2, v2, v164
    v_lshlrev_b32 v2, 4, v2
    v_add_u32 v3, s39, v3
    v_mul_lo_u32 v3, v3, s26
    v_add3_u32 v2, v2, v3, s38
    s_mov_b32 m0, 153312
    s_nop 0
    buffer_load_dwordx4 v2, s[48:51], 0 offen lds
    v_add_u32 v2, 384, v1
    v_mul_u32_u24 v3, 6554, v2
    v_lshrrev_b32 v3, 16, v3
    v_mul_u32_u24 v164, 10, v3
    v_sub_u32 v2, v2, v164
    v_lshrrev_b32 v164, 3, v3
    v_sub_u32 v2, v2, v164
    v_add_u32 v164, 10, v2
    v_min_u32 v2, v2, v164
    v_lshlrev_b32 v2, 4, v2
    v_add_u32 v3, s39, v3
    v_mul_lo_u32 v3, v3, s26
    v_add3_u32 v2, v2, v3, s38
    s_mov_b32 m0, 154336
    s_nop 0
    buffer_load_dwordx4 v2, s[48:51], 0 offen lds
    v_add_u32 v2, 448, v1
    v_mul_u32_u24 v3, 6554, v2
    v_lshrrev_b32 v3, 16, v3
    v_mul_u32_u24 v164, 10, v3
    v_sub_u32 v2, v2, v164
    v_lshrrev_b32 v164, 3, v3
    v_sub_u32 v2, v2, v164
    v_add_u32 v164, 10, v2
    v_min_u32 v2, v2, v164
    v_lshlrev_b32 v2, 4, v2
    v_add_u32 v3, s39, v3
    v_mul_lo_u32 v3, v3, s26
    v_add3_u32 v2, v2, v3, s38
    s_mov_b32 m0, 155360
    s_nop 0
    buffer_load_dwordx4 v2, s[48:51], 0 offen lds
    v_add_u32 v2, 512, v1
    v_mul_u32_u24 v3, 6554, v2
    v_lshrrev_b32 v3, 16, v3
    v_mul_u32_u24 v164, 10, v3
    v_sub_u32 v2, v2, v164
    v_lshrrev_b32 v164, 3, v3
    v_sub_u32 v2, v2, v164
    v_add_u32 v164, 10, v2
    v_min_u32 v2, v2, v164
    v_lshlrev_b32 v2, 4, v2
    v_add_u32 v3, s39, v3
    v_mul_lo_u32 v3, v3, s26
    v_add3_u32 v2, v2, v3, s38
    s_mov_b32 m0, 156384
    s_nop 0
    buffer_load_dwordx4 v2, s[48:51], 0 offen lds
    v_add_u32 v2, 576, v1
    v_mul_u32_u24 v3, 6554, v2
    v_lshrrev_b32 v3, 16, v3
    v_mul_u32_u24 v164, 10, v3
    v_sub_u32 v2, v2, v164
    v_lshrrev_b32 v164, 3, v3
    v_sub_u32 v2, v2, v164
    v_add_u32 v164, 10, v2
    v_min_u32 v2, v2, v164
    v_lshlrev_b32 v2, 4, v2
    v_add_u32 v3, s39, v3
    v_mul_lo_u32 v3, v3, s26
    v_add3_u32 v2, v2, v3, s38
    s_mov_b32 m0, 157408
    s_nop 0
    buffer_load_dwordx4 v2, s[48:51], 0 offen lds
    v_lshrrev_b32 v6, 2, v1
    v_lshlrev_b32 v6, 7, v6
    v_and_b32 v3, 3, v1
    v_lshlrev_b32 v3, 4, v3
    v_add_u32 v6, v6, v3
    s_and_b32 s36, s2, 7
    s_lshl_b32 s36, s36, 11
    s_add_u32 s36, s36, 8126464
    s_lshl_b32 s37, s20, 3
    s_add_u32 s37, s37, s21
    s_lshl_b32 s37, s37, 7
    s_lshl_b32 s38, s21, 7
    s_lshl_b32 s39, s20, 2
    s_add_u32 s38, s38, s39
    v_lshlrev_b32 v7, 2, v1
    v_mov_b32 v14, 162376
    buffer_load_dwordx4 v[8:11], v6, s[12:15], s36 offen sc1
    s_waitcnt vmcnt(1)
    v_mov_b32 v12, 162404
    v_mov_b32 v13, 1
    ds_write_b32 v12, v13
    s_mov_b32 s40, 4294967295
    s_mov_b32 s41, 4294967295
    s_mov_b32 s43, 0
poll_113:
    buffer_load_dwordx4 v[8:11], v6, s[12:15], s36 offen sc1
    s_waitcnt vmcnt(0)
    v_xor_b32 v8, s25, v8
    v_xor_b32 v9, s25, v9
    v_xor_b32 v10, s25, v10
    v_xor_b32 v11, s25, v11
    v_or_b32 v8, v8, v9
    v_or_b32 v10, v10, v11
    v_or_b32 v8, v8, v10
    v_cmp_ne_u32 vcc, 0, v8
    s_nop 1
    s_and_b64 vcc, vcc, s[40:41]
    s_cmp_eq_u64 vcc, 0
    s_cbranch_scc1 pdone_114
    s_add_u32 s43, s43, 1
    s_cmp_lt_u32 s43, 40000
    s_cbranch_scc0 pdone_114
    s_branch poll_113
pdone_114:
    v_lshlrev_b32 v20, 4, v1
    s_mov_b32 s84, 0
    s_mov_b32 s78, 0
    s_mov_b32 s82, 0
    s_mov_b32 s79, 0
    s_mov_b32 s83, 0
    s_lshr_b32 s28, s82, 1
    s_add_u32 s28, s28, s27
    s_and_b32 s28, s28, 7
    s_mul_i32 s28, s28, 12288
    s_add_u32 s81, s28, 0
    buffer_load_dwordx4 v[32:35], v20, s[12:15], s81 offen offset:0 sc1
    buffer_load_dwordx4 v[36:39], v20, s[12:15], s81 offen offset:1024 sc1
    buffer_load_dwordx4 v[40:43], v20, s[12:15], s81 offen offset:2048 sc1
    buffer_load_dwordx4 v[44:47], v20, s[12:15], s81 offen offset:3072 sc1
    s_add_u32 s81, s81, 4096
    buffer_load_dwordx4 v[48:51], v20, s[12:15], s81 offen offset:0 sc1
    buffer_load_dwordx4 v[52:55], v20, s[12:15], s81 offen offset:1024 sc1
    s_add_u32 s82, s82, 1
    s_add_u32 s84, s84, 1
    s_mov_b32 s85, s84
    s_lshr_b32 s28, s83, 1
    s_add_u32 s28, s28, s27
    s_and_b32 s28, s28, 7
    s_mul_i32 s28, s28, 12288
    s_add_u32 s81, s28, 98304
    buffer_load_dwordx4 v[80:83], v20, s[12:15], s81 offen offset:0 sc1
    buffer_load_dwordx4 v[84:87], v20, s[12:15], s81 offen offset:1024 sc1
    buffer_load_dwordx4 v[88:91], v20, s[12:15], s81 offen offset:2048 sc1
    buffer_load_dwordx4 v[92:95], v20, s[12:15], s81 offen offset:3072 sc1
    s_add_u32 s81, s81, 4096
    buffer_load_dwordx4 v[96:99], v20, s[12:15], s81 offen offset:0 sc1
    buffer_load_dwordx4 v[100:103], v20, s[12:15], s81 offen offset:1024 sc1
    s_add_u32 s83, s83, 1
    s_add_u32 s84, s84, 1
    s_mov_b32 s87, s84
    s_lshr_b32 s28, s82, 1
    s_add_u32 s28, s28, s27
    s_and_b32 s28, s28, 7
    s_mul_i32 s28, s28, 12288
    s_add_u32 s81, s28, 6144
    buffer_load_dwordx4 v[56:59], v20, s[12:15], s81 offen offset:0 sc1
    buffer_load_dwordx4 v[60:63], v20, s[12:15], s81 offen offset:1024 sc1
    buffer_load_dwordx4 v[64:67], v20, s[12:15], s81 offen offset:2048 sc1
    buffer_load_dwordx4 v[68:71], v20, s[12:15], s81 offen offset:3072 sc1
    s_add_u32 s81, s81, 4096
    buffer_load_dwordx4 v[72:75], v20, s[12:15], s81 offen offset:0 sc1
    buffer_load_dwordx4 v[76:79], v20, s[12:15], s81 offen offset:1024 sc1
    s_add_u32 s82, s82, 1
    s_add_u32 s84, s84, 1
    s_mov_b32 s86, s84
    s_lshr_b32 s28, s83, 1
    s_add_u32 s28, s28, s27
    s_and_b32 s28, s28, 7
    s_mul_i32 s28, s28, 12288
    s_add_u32 s81, s28, 104448
    buffer_load_dwordx4 v[104:107], v20, s[12:15], s81 offen offset:0 sc1
    buffer_load_dwordx4 v[108:111], v20, s[12:15], s81 offen offset:1024 sc1
    buffer_load_dwordx4 v[112:115], v20, s[12:15], s81 offen offset:2048 sc1
    buffer_load_dwordx4 v[116:119], v20, s[12:15], s81 offen offset:3072 sc1
    s_add_u32 s81, s81, 4096
    buffer_load_dwordx4 v[120:123], v20, s[12:15], s81 offen offset:0 sc1
    buffer_load_dwordx4 v[124:127], v20, s[12:15], s81 offen offset:1024 sc1
    s_add_u32 s83, s83, 1
    s_add_u32 s84, s84, 1
    s_mov_b32 s88, s84
    v_mov_b32 v2, 162552
    s_mov_b32 s43, 0
lw_115:
    ds_read_b32 v3, v2
    s_waitcnt lgkmcnt(0)
    v_readfirstlane_b32 s42, v3
    s_nop 3
    s_cmp_ge_u32 s42, 8
    s_cbranch_scc1 lwd_116
    s_add_u32 s43, s43, 1
    s_cmp_lt_u32 s43, 320000
    s_cbranch_scc0 lwd_116
    s_branch lw_115
lwd_116:
    v_and_b32 v22, 7, v1
    v_lshlrev_b32 v22, 2, v22
    v_add_u32 v22, 162336, v22
    s_mov_b32 s33, 0
fl_117:
    ds_read_b32 v24, v22
    s_waitcnt lgkmcnt(0)
    s_mov_b32 s39, 0
    s_cmp_ge_u32 s78, 16
    s_cbranch_scc1 fs_119
    s_and_b32 s29, s78, 3
    s_add_u32 s29, s29, 0
    v_readlane_b32 s42, v24, s29
    s_lshr_b32 s28, s78, 2
    s_lshl_b32 s28, s28, 2
    s_nop 1
    s_cmp_lt_u32 s42, s28
    s_cbranch_scc1 fs_119
    s_and_b32 s28, s78, 1
    s_cmp_lg_u32 s28, 0
    s_cbranch_scc1 fp_120
    s_sub_u32 s28, s84, s85
    s_cmp_lg_u32 s28, 0
    s_cbranch_scc1 fw_122
    s_waitcnt vmcnt(0)
    s_branch fw_121
fw_122:
    s_cmp_lg_u32 s28, 1
    s_cbranch_scc1 fw_123
    s_waitcnt vmcnt(6)
    s_branch fw_121
fw_123:
    s_cmp_lg_u32 s28, 2
    s_cbranch_scc1 fw_124
    s_waitcnt vmcnt(12)
    s_branch fw_121
fw_124:
    s_waitcnt vmcnt(18)
fw_121:
    s_and_b32 s28, s78, 3
    s_mul_i32 s29, s28, 6144
    s_add_u32 s29, s29, 0
    v_add_u32 v26, s29, v20
    ds_write_b128 v26, v[32:35] offset:0
    ds_write_b128 v26, v[36:39] offset:1024
    ds_write_b128 v26, v[40:43] offset:2048
    ds_write_b128 v26, v[44:47] offset:3072
    ds_write_b128 v26, v[48:51] offset:4096
    ds_write_b128 v26, v[52:55] offset:5120
    s_lshl_b32 s28, s28, 2
    s_add_u32 s28, s28, 162304
    v_mov_b32 v27, s28
    v_mov_b32 v28, 1
    s_mov_b64 exec, 1
    ds_add_u32 v27, v28
    s_mov_b64 exec, -1
    s_add_u32 s78, s78, 1
    s_mov_b32 s39, 1
    s_cmp_ge_u32 s82, 16
    s_cbranch_scc1 fs_119
    s_lshr_b32 s28, s82, 1
    s_add_u32 s28, s28, s27
    s_and_b32 s28, s28, 7
    s_mul_i32 s28, s28, 12288
    s_add_u32 s81, s28, 0
    buffer_load_dwordx4 v[32:35], v20, s[12:15], s81 offen offset:0 sc1
    buffer_load_dwordx4 v[36:39], v20, s[12:15], s81 offen offset:1024 sc1
    buffer_load_dwordx4 v[40:43], v20, s[12:15], s81 offen offset:2048 sc1
    buffer_load_dwordx4 v[44:47], v20, s[12:15], s81 offen offset:3072 sc1
    s_add_u32 s81, s81, 4096
    buffer_load_dwordx4 v[48:51], v20, s[12:15], s81 offen offset:0 sc1
    buffer_load_dwordx4 v[52:55], v20, s[12:15], s81 offen offset:1024 sc1
    s_add_u32 s82, s82, 1
    s_add_u32 s84, s84, 1
    s_mov_b32 s85, s84
    s_branch fs_119
fp_120:
    s_and_b32 s28, s78, 1
    s_cmp_lg_u32 s28, 1
    s_cbranch_scc1 fp_125
    s_sub_u32 s28, s84, s86
    s_cmp_lg_u32 s28, 0
    s_cbranch_scc1 fw_127
    s_waitcnt vmcnt(0)
    s_branch fw_126
fw_127:
    s_cmp_lg_u32 s28, 1
    s_cbranch_scc1 fw_128
    s_waitcnt vmcnt(6)
    s_branch fw_126
fw_128:
    s_cmp_lg_u32 s28, 2
    s_cbranch_scc1 fw_129
    s_waitcnt vmcnt(12)
    s_branch fw_126
fw_129:
    s_waitcnt vmcnt(18)
fw_126:
    s_and_b32 s28, s78, 3
    s_mul_i32 s29, s28, 6144
    s_add_u32 s29, s29, 0
    v_add_u32 v26, s29, v20
    ds_write_b128 v26, v[56:59] offset:0
    ds_write_b128 v26, v[60:63] offset:1024
    ds_write_b128 v26, v[64:67] offset:2048
    ds_write_b128 v26, v[68:71] offset:3072
    ds_write_b128 v26, v[72:75] offset:4096
    ds_write_b128 v26, v[76:79] offset:5120
    s_lshl_b32 s28, s28, 2
    s_add_u32 s28, s28, 162304
    v_mov_b32 v27, s28
    v_mov_b32 v28, 1
    s_mov_b64 exec, 1
    ds_add_u32 v27, v28
    s_mov_b64 exec, -1
    s_add_u32 s78, s78, 1
    s_mov_b32 s39, 1
    s_cmp_ge_u32 s82, 16
    s_cbranch_scc1 fs_119
    s_lshr_b32 s28, s82, 1
    s_add_u32 s28, s28, s27
    s_and_b32 s28, s28, 7
    s_mul_i32 s28, s28, 12288
    s_add_u32 s81, s28, 6144
    buffer_load_dwordx4 v[56:59], v20, s[12:15], s81 offen offset:0 sc1
    buffer_load_dwordx4 v[60:63], v20, s[12:15], s81 offen offset:1024 sc1
    buffer_load_dwordx4 v[64:67], v20, s[12:15], s81 offen offset:2048 sc1
    buffer_load_dwordx4 v[68:71], v20, s[12:15], s81 offen offset:3072 sc1
    s_add_u32 s81, s81, 4096
    buffer_load_dwordx4 v[72:75], v20, s[12:15], s81 offen offset:0 sc1
    buffer_load_dwordx4 v[76:79], v20, s[12:15], s81 offen offset:1024 sc1
    s_add_u32 s82, s82, 1
    s_add_u32 s84, s84, 1
    s_mov_b32 s86, s84
    s_branch fs_119
fp_125:
fs_119:
    s_cmp_ge_u32 s79, 16
    s_cbranch_scc1 fs_130
    s_and_b32 s29, s79, 3
    s_add_u32 s29, s29, 4
    v_readlane_b32 s42, v24, s29
    s_lshr_b32 s28, s79, 2
    s_lshl_b32 s28, s28, 2
    s_nop 1
    s_cmp_lt_u32 s42, s28
    s_cbranch_scc1 fs_130
    s_and_b32 s28, s79, 1
    s_cmp_lg_u32 s28, 0
    s_cbranch_scc1 fp_131
    s_sub_u32 s28, s84, s87
    s_cmp_lg_u32 s28, 0
    s_cbranch_scc1 fw_133
    s_waitcnt vmcnt(0)
    s_branch fw_132
fw_133:
    s_cmp_lg_u32 s28, 1
    s_cbranch_scc1 fw_134
    s_waitcnt vmcnt(6)
    s_branch fw_132
fw_134:
    s_cmp_lg_u32 s28, 2
    s_cbranch_scc1 fw_135
    s_waitcnt vmcnt(12)
    s_branch fw_132
fw_135:
    s_waitcnt vmcnt(18)
fw_132:
    s_and_b32 s28, s79, 3
    s_mul_i32 s29, s28, 6144
    s_add_u32 s29, s29, 24576
    v_add_u32 v26, s29, v20
    ds_write_b128 v26, v[80:83] offset:0
    ds_write_b128 v26, v[84:87] offset:1024
    ds_write_b128 v26, v[88:91] offset:2048
    ds_write_b128 v26, v[92:95] offset:3072
    ds_write_b128 v26, v[96:99] offset:4096
    ds_write_b128 v26, v[100:103] offset:5120
    s_lshl_b32 s28, s28, 2
    s_add_u32 s28, s28, 162320
    v_mov_b32 v27, s28
    v_mov_b32 v28, 1
    s_mov_b64 exec, 1
    ds_add_u32 v27, v28
    s_mov_b64 exec, -1
    s_add_u32 s79, s79, 1
    s_mov_b32 s39, 1
    s_cmp_ge_u32 s83, 16
    s_cbranch_scc1 fs_130
    s_lshr_b32 s28, s83, 1
    s_add_u32 s28, s28, s27
    s_and_b32 s28, s28, 7
    s_mul_i32 s28, s28, 12288
    s_add_u32 s81, s28, 98304
    buffer_load_dwordx4 v[80:83], v20, s[12:15], s81 offen offset:0 sc1
    buffer_load_dwordx4 v[84:87], v20, s[12:15], s81 offen offset:1024 sc1
    buffer_load_dwordx4 v[88:91], v20, s[12:15], s81 offen offset:2048 sc1
    buffer_load_dwordx4 v[92:95], v20, s[12:15], s81 offen offset:3072 sc1
    s_add_u32 s81, s81, 4096
    buffer_load_dwordx4 v[96:99], v20, s[12:15], s81 offen offset:0 sc1
    buffer_load_dwordx4 v[100:103], v20, s[12:15], s81 offen offset:1024 sc1
    s_add_u32 s83, s83, 1
    s_add_u32 s84, s84, 1
    s_mov_b32 s87, s84
    s_branch fs_130
fp_131:
    s_and_b32 s28, s79, 1
    s_cmp_lg_u32 s28, 1
    s_cbranch_scc1 fp_136
    s_sub_u32 s28, s84, s88
    s_cmp_lg_u32 s28, 0
    s_cbranch_scc1 fw_138
    s_waitcnt vmcnt(0)
    s_branch fw_137
fw_138:
    s_cmp_lg_u32 s28, 1
    s_cbranch_scc1 fw_139
    s_waitcnt vmcnt(6)
    s_branch fw_137
fw_139:
    s_cmp_lg_u32 s28, 2
    s_cbranch_scc1 fw_140
    s_waitcnt vmcnt(12)
    s_branch fw_137
fw_140:
    s_waitcnt vmcnt(18)
fw_137:
    s_and_b32 s28, s79, 3
    s_mul_i32 s29, s28, 6144
    s_add_u32 s29, s29, 24576
    v_add_u32 v26, s29, v20
    ds_write_b128 v26, v[104:107] offset:0
    ds_write_b128 v26, v[108:111] offset:1024
    ds_write_b128 v26, v[112:115] offset:2048
    ds_write_b128 v26, v[116:119] offset:3072
    ds_write_b128 v26, v[120:123] offset:4096
    ds_write_b128 v26, v[124:127] offset:5120
    s_lshl_b32 s28, s28, 2
    s_add_u32 s28, s28, 162320
    v_mov_b32 v27, s28
    v_mov_b32 v28, 1
    s_mov_b64 exec, 1
    ds_add_u32 v27, v28
    s_mov_b64 exec, -1
    s_add_u32 s79, s79, 1
    s_mov_b32 s39, 1
    s_cmp_ge_u32 s83, 16
    s_cbranch_scc1 fs_130
    s_lshr_b32 s28, s83, 1
    s_add_u32 s28, s28, s27
    s_and_b32 s28, s28, 7
    s_mul_i32 s28, s28, 12288
    s_add_u32 s81, s28, 104448
    buffer_load_dwordx4 v[104:107], v20, s[12:15], s81 offen offset:0 sc1
    buffer_load_dwordx4 v[108:111], v20, s[12:15], s81 offen offset:1024 sc1
    buffer_load_dwordx4 v[112:115], v20, s[12:15], s81 offen offset:2048 sc1
    buffer_load_dwordx4 v[116:119], v20, s[12:15], s81 offen offset:3072 sc1
    s_add_u32 s81, s81, 4096
    buffer_load_dwordx4 v[120:123], v20, s[12:15], s81 offen offset:0 sc1
    buffer_load_dwordx4 v[124:127], v20, s[12:15], s81 offen offset:1024 sc1
    s_add_u32 s83, s83, 1
    s_add_u32 s84, s84, 1
    s_mov_b32 s88, s84
    s_branch fs_130
fp_136:
fs_130:
    s_add_u32 s28, s78, s79
    s_cmp_ge_u32 s28, 32
    s_cbranch_scc1 fd_118
    s_add_u32 s33, s33, 1
    s_cmp_ge_u32 s33, 320000
    s_cbranch_scc1 fd_118
    s_cmp_lg_u32 s39, 0
    s_cbranch_scc1 fl_117
    s_sleep 3
    s_branch fl_117
fd_118:
    s_lshl_b32 s37, s20, 3
    s_add_u32 s37, s37, s21
    s_lshl_b32 s37, s37, 7
    v_lshlrev_b32 v7, 2, v1
    v_mov_b32 v2, 162396
    s_mov_b32 s43, 0
lw_141:
    ds_read_b32 v3, v2
    s_waitcnt lgkmcnt(0)
    v_readfirstlane_b32 s42, v3
    s_nop 3
    s_cmp_ge_u32 s42, 8
    s_cbranch_scc1 lwd_142
    s_add_u32 s43, s43, 1
    s_cmp_lt_u32 s43, 320000
    s_cbranch_scc0 lwd_142
    s_branch lw_141
lwd_142:
    s_lshl_b32 s29, s20, 10
    s_lshl_b32 s30, s21, 2
    s_add_u32 s29, s29, s30
    s_add_u32 s29, s29, 8208384
    v_lshlrev_b32 v2, 7, v1
    v_mov_b32 v3, s25
    s_mov_b64 exec, 0xff
    buffer_store_dword v3, v2, s[12:15], s29 offen sc1
    s_mov_b64 exec, -1
    s_add_u32 s29, s37, 8208384
    s_mov_b32 s40, 255
    s_mov_b32 s41, 0
    s_mov_b32 s43, 0
poll_143:
    buffer_load_dword v8, v7, s[12:15], s29 offen sc1
    s_waitcnt vmcnt(0)
    v_cmp_ne_u32 vcc, s25, v8
    s_nop 1
    s_and_b64 vcc, vcc, s[40:41]
    s_cmp_eq_u64 vcc, 0
    s_cbranch_scc1 pdone_144
    s_add_u32 s43, s43, 1
    s_cmp_lt_u32 s43, 40000
    s_cbranch_scc0 pdone_144
    s_branch poll_143
pdone_144:
    v_mov_b32 v12, 162400
    v_mov_b32 v13, 1
    ds_write_b32 v12, v13
    s_branch f_fin
f_lstart:
    s_setprio 3
    s_sub_u32 s34, s22, 9
    v_lshlrev_b32 v165, 4, v1
    s_barrier
    v_lshrrev_b32 v2, 4, v1
    v_add_u32 v2, 0, v2
    v_xor_b32 v3, v1, v2
    v_and_b32 v3, 15, v3
    v_lshlrev_b32 v3, 4, v3
    s_lshl_b32 s28, s20, 6
    v_add_u32 v2, s28, v2
    v_mul_lo_u32 v2, v2, s26
    v_add_u32 v112, v2, v3
    v_lshrrev_b32 v2, 4, v1
    v_add_u32 v2, 4, v2
    v_xor_b32 v3, v1, v2
    v_and_b32 v3, 15, v3
    v_lshlrev_b32 v3, 4, v3
    s_lshl_b32 s28, s20, 6
    v_add_u32 v2, s28, v2
    v_mul_lo_u32 v2, v2, s26
    v_add_u32 v113, v2, v3
    v_lshrrev_b32 v2, 4, v1
    v_add_u32 v2, 8, v2
    v_xor_b32 v3, v1, v2
    v_and_b32 v3, 15, v3
    v_lshlrev_b32 v3, 4, v3
    s_lshl_b32 s28, s20, 6
    v_add_u32 v2, s28, v2
    v_mul_lo_u32 v2, v2, s26
    v_add_u32 v114, v2, v3
    v_lshrrev_b32 v2, 4, v1
    v_add_u32 v2, 12, v2
    v_xor_b32 v3, v1, v2
    v_and_b32 v3, 15, v3
    v_lshlrev_b32 v3, 4, v3
    s_lshl_b32 s28, s20, 6
    v_add_u32 v2, s28, v2
    v_mul_lo_u32 v2, v2, s26
    v_add_u32 v115, v2, v3
    s_mul_i32 s29, s21, 160
    v_add_u32 v2, 0, v1
    v_mul_u32_u24 v3, 6554, v2
    v_lshrrev_b32 v3, 16, v3
    v_mul_u32_u24 v164, 10, v3
    v_sub_u32 v2, v2, v164
    v_lshlrev_b32 v2, 4, v2
    v_and_b32 v164, 0xfff8, v3
    v_bfe_u32 v121, v3, 1, 2
    v_or_b32 v164, v164, v121
    v_and_b32 v3, 1, v3
    v_lshlrev_b32 v3, 2, v3
    v_or_b32 v164, v164, v3
    v_mul_lo_u32 v164, v164, s26
    v_add_u32 v164, v164, v2
    v_add_u32 v116, s29, v164
    v_add_u32 v2, 64, v1
    v_mul_u32_u24 v3, 6554, v2
    v_lshrrev_b32 v3, 16, v3
    v_mul_u32_u24 v164, 10, v3
    v_sub_u32 v2, v2, v164
    v_lshlrev_b32 v2, 4, v2
    v_and_b32 v164, 0xfff8, v3
    v_bfe_u32 v121, v3, 1, 2
    v_or_b32 v164, v164, v121
    v_and_b32 v3, 1, v3
    v_lshlrev_b32 v3, 2, v3
    v_or_b32 v164, v164, v3
    v_mul_lo_u32 v164, v164, s26
    v_add_u32 v164, v164, v2
    v_add_u32 v117, s29, v164
    v_add_u32 v2, 128, v1
    v_mul_u32_u24 v3, 6554, v2
    v_lshrrev_b32 v3, 16, v3
    v_mul_u32_u24 v164, 10, v3
    v_sub_u32 v2, v2, v164
    v_lshlrev_b32 v2, 4, v2
    v_and_b32 v164, 0xfff8, v3
    v_bfe_u32 v121, v3, 1, 2
    v_or_b32 v164, v164, v121
    v_and_b32 v3, 1, v3
    v_lshlrev_b32 v3, 2, v3
    v_or_b32 v164, v164, v3
    v_mul_lo_u32 v164, v164, s26
    v_add_u32 v164, v164, v2
    v_add_u32 v118, s29, v164
    v_add_u32 v2, 192, v1
    v_mul_u32_u24 v3, 6554, v2
    v_lshrrev_b32 v3, 16, v3
    v_mul_u32_u24 v164, 10, v3
    v_sub_u32 v2, v2, v164
    v_lshlrev_b32 v2, 4, v2
    v_and_b32 v164, 0xfff8, v3
    v_bfe_u32 v121, v3, 1, 2
    v_or_b32 v164, v164, v121
    v_and_b32 v3, 1, v3
    v_lshlrev_b32 v3, 2, v3
    v_or_b32 v164, v164, v3
    v_mul_lo_u32 v164, v164, s26
    v_add_u32 v164, v164, v2
    v_add_u32 v119, s29, v164
    v_add_u32 v2, 256, v1
    v_mul_u32_u24 v3, 6554, v2
    v_lshrrev_b32 v3, 16, v3
    v_mul_u32_u24 v164, 10, v3
    v_sub_u32 v2, v2, v164
    v_lshlrev_b32 v2, 4, v2
    v_and_b32 v164, 0xfff8, v3
    v_bfe_u32 v121, v3, 1, 2
    v_or_b32 v164, v164, v121
    v_and_b32 v3, 1, v3
    v_lshlrev_b32 v3, 2, v3
    v_or_b32 v164, v164, v3
    v_mul_lo_u32 v164, v164, s26
    v_add_u32 v164, v164, v2
    v_add_u32 v120, s29, v164
    s_cmp_lg_u32 s34, 0
    s_cbranch_scc1 ldv_146
    s_add_u32 s94, s97, 2
    s_sub_u32 s92, s94, 5
    s_cmp_ge_u32 s94, 5
    s_cselect_b32 s94, s92, s94
    s_lshl_b32 s92, s94, 8
    s_mul_i32 s93, s94, 163840
    s_add_u32 s28, s92, 0
    s_mov_b32 m0, 73728
    s_nop 0
    buffer_load_dwordx4 v112, s[4:7], s28 offen lds
    s_add_u32 s28, s92, 0
    s_mov_b32 m0, 74752
    s_nop 0
    buffer_load_dwordx4 v113, s[4:7], s28 offen lds
    s_add_u32 s28, s92, 0
    s_mov_b32 m0, 75776
    s_nop 0
    buffer_load_dwordx4 v114, s[4:7], s28 offen lds
    s_add_u32 s28, s92, 0
    s_mov_b32 m0, 76800
    s_nop 0
    buffer_load_dwordx4 v115, s[4:7], s28 offen lds
    s_add_u32 s28, s92, 20480
    s_mov_b32 m0, 77824
    s_nop 0
    buffer_load_dwordx4 v112, s[4:7], s28 offen lds
    s_add_u32 s28, s92, 20480
    s_mov_b32 m0, 78848
    s_nop 0
    buffer_load_dwordx4 v113, s[4:7], s28 offen lds
    s_add_u32 s28, s92, 20480
    s_mov_b32 m0, 79872
    s_nop 0
    buffer_load_dwordx4 v114, s[4:7], s28 offen lds
    s_add_u32 s28, s92, 20480
    s_mov_b32 m0, 80896
    s_nop 0
    buffer_load_dwordx4 v115, s[4:7], s28 offen lds
    s_add_u32 s28, s92, 40960
    s_mov_b32 m0, 81920
    s_nop 0
    buffer_load_dwordx4 v112, s[4:7], s28 offen lds
    s_add_u32 s28, s92, 40960
    s_mov_b32 m0, 82944
    s_nop 0
    buffer_load_dwordx4 v113, s[4:7], s28 offen lds
    s_add_u32 s28, s92, 40960
    s_mov_b32 m0, 83968
    s_nop 0
    buffer_load_dwordx4 v114, s[4:7], s28 offen lds
    s_add_u32 s28, s92, 40960
    s_mov_b32 m0, 84992
    s_nop 0
    buffer_load_dwordx4 v115, s[4:7], s28 offen lds
    s_waitcnt vmcnt(0)
    v_mov_b32 v2, 162440
    v_mov_b32 v3, 1
    s_mov_b64 exec, 1
    ds_add_u32 v2, v3
    s_mov_b64 exec, -1
    v_mov_b32 v2, 162416
    s_mov_b32 s43, 0
lw_147:
    ds_read_b32 v3, v2
    s_waitcnt lgkmcnt(0)
    v_readfirstlane_b32 s42, v3
    s_nop 3
    s_cmp_ge_u32 s42, 8
    s_cbranch_scc1 lwd_148
    s_add_u32 s43, s43, 1
    s_cmp_lt_u32 s43, 320000
    s_cbranch_scc0 lwd_148
    s_branch lw_147
lwd_148:
    s_add_u32 s94, s97, 3
    s_sub_u32 s92, s94, 5
    s_cmp_ge_u32 s94, 5
    s_cselect_b32 s94, s92, s94
    s_lshl_b32 s92, s94, 8
    s_mul_i32 s93, s94, 163840
    s_add_u32 s28, s92, 0
    s_mov_b32 m0, 0
    s_nop 0
    buffer_load_dwordx4 v112, s[4:7], s28 offen lds
    s_add_u32 s28, s92, 0
    s_mov_b32 m0, 1024
    s_nop 0
    buffer_load_dwordx4 v113, s[4:7], s28 offen lds
    s_add_u32 s28, s92, 0
    s_mov_b32 m0, 2048
    s_nop 0
    buffer_load_dwordx4 v114, s[4:7], s28 offen lds
    s_add_u32 s28, s92, 0
    s_mov_b32 m0, 3072
    s_nop 0
    buffer_load_dwordx4 v115, s[4:7], s28 offen lds
    s_add_u32 s28, s92, 20480
    s_mov_b32 m0, 4096
    s_nop 0
    buffer_load_dwordx4 v112, s[4:7], s28 offen lds
    s_add_u32 s28, s92, 20480
    s_mov_b32 m0, 5120
    s_nop 0
    buffer_load_dwordx4 v113, s[4:7], s28 offen lds
    s_add_u32 s28, s92, 20480
    s_mov_b32 m0, 6144
    s_nop 0
    buffer_load_dwordx4 v114, s[4:7], s28 offen lds
    s_add_u32 s28, s92, 20480
    s_mov_b32 m0, 7168
    s_nop 0
    buffer_load_dwordx4 v115, s[4:7], s28 offen lds
    s_add_u32 s28, s92, 40960
    s_mov_b32 m0, 8192
    s_nop 0
    buffer_load_dwordx4 v112, s[4:7], s28 offen lds
    s_add_u32 s28, s92, 40960
    s_mov_b32 m0, 9216
    s_nop 0
    buffer_load_dwordx4 v113, s[4:7], s28 offen lds
    s_add_u32 s28, s92, 40960
    s_mov_b32 m0, 10240
    s_nop 0
    buffer_load_dwordx4 v114, s[4:7], s28 offen lds
    s_add_u32 s28, s92, 40960
    s_mov_b32 m0, 11264
    s_nop 0
    buffer_load_dwordx4 v115, s[4:7], s28 offen lds
    v_mov_b32 v2, 162420
    s_mov_b32 s43, 0
lw_149:
    ds_read_b32 v3, v2
    s_waitcnt lgkmcnt(0)
    v_readfirstlane_b32 s42, v3
    s_nop 3
    s_cmp_ge_u32 s42, 8
    s_cbranch_scc1 lwd_150
    s_add_u32 s43, s43, 1
    s_cmp_lt_u32 s43, 320000
    s_cbranch_scc0 lwd_150
    s_branch lw_149
lwd_150:
    s_add_u32 s94, s97, 4
    s_sub_u32 s92, s94, 5
    s_cmp_ge_u32 s94, 5
    s_cselect_b32 s94, s92, s94
    s_lshl_b32 s92, s94, 8
    s_mul_i32 s93, s94, 163840
    s_add_u32 s28, s92, 0
    s_mov_b32 m0, 36864
    s_nop 0
    buffer_load_dwordx4 v112, s[4:7], s28 offen lds
    s_add_u32 s28, s92, 0
    s_mov_b32 m0, 37888
    s_nop 0
    buffer_load_dwordx4 v113, s[4:7], s28 offen lds
    s_add_u32 s28, s92, 0
    s_mov_b32 m0, 38912
    s_nop 0
    buffer_load_dwordx4 v114, s[4:7], s28 offen lds
    s_add_u32 s28, s92, 0
    s_mov_b32 m0, 39936
    s_nop 0
    buffer_load_dwordx4 v115, s[4:7], s28 offen lds
    s_add_u32 s28, s92, 20480
    s_mov_b32 m0, 40960
    s_nop 0
    buffer_load_dwordx4 v112, s[4:7], s28 offen lds
    s_add_u32 s28, s92, 20480
    s_mov_b32 m0, 41984
    s_nop 0
    buffer_load_dwordx4 v113, s[4:7], s28 offen lds
    s_add_u32 s28, s92, 20480
    s_mov_b32 m0, 43008
    s_nop 0
    buffer_load_dwordx4 v114, s[4:7], s28 offen lds
    s_add_u32 s28, s92, 20480
    s_mov_b32 m0, 44032
    s_nop 0
    buffer_load_dwordx4 v115, s[4:7], s28 offen lds
    s_add_u32 s28, s92, 40960
    s_mov_b32 m0, 45056
    s_nop 0
    buffer_load_dwordx4 v112, s[4:7], s28 offen lds
    s_add_u32 s28, s92, 40960
    s_mov_b32 m0, 46080
    s_nop 0
    buffer_load_dwordx4 v113, s[4:7], s28 offen lds
    s_add_u32 s28, s92, 40960
    s_mov_b32 m0, 47104
    s_nop 0
    buffer_load_dwordx4 v114, s[4:7], s28 offen lds
    s_add_u32 s28, s92, 40960
    s_mov_b32 m0, 48128
    s_nop 0
    buffer_load_dwordx4 v115, s[4:7], s28 offen lds
    s_waitcnt vmcnt(12)
    v_mov_b32 v2, 162444
    v_mov_b32 v3, 1
    s_mov_b64 exec, 1
    ds_add_u32 v2, v3
    s_mov_b64 exec, -1
    s_waitcnt vmcnt(0)
    v_mov_b32 v2, 162448
    v_mov_b32 v3, 1
    s_mov_b64 exec, 1
    ds_add_u32 v2, v3
    s_mov_b64 exec, -1
    s_branch ldj_145
ldv_146:
    s_cmp_lg_u32 s34, 1
    s_cbranch_scc1 ldv_151
    s_add_u32 s94, s97, 2
    s_sub_u32 s92, s94, 5
    s_cmp_ge_u32 s94, 5
    s_cselect_b32 s94, s92, s94
    s_lshl_b32 s92, s94, 8
    s_mul_i32 s93, s94, 163840
    s_add_u32 s28, s92, 61440
    s_mov_b32 m0, 86016
    s_nop 0
    buffer_load_dwordx4 v112, s[4:7], s28 offen lds
    s_add_u32 s28, s92, 61440
    s_mov_b32 m0, 87040
    s_nop 0
    buffer_load_dwordx4 v113, s[4:7], s28 offen lds
    s_add_u32 s28, s92, 61440
    s_mov_b32 m0, 88064
    s_nop 0
    buffer_load_dwordx4 v114, s[4:7], s28 offen lds
    s_add_u32 s28, s92, 61440
    s_mov_b32 m0, 89088
    s_nop 0
    buffer_load_dwordx4 v115, s[4:7], s28 offen lds
    s_add_u32 s28, s93, 0
    s_mov_b32 m0, 90112
    s_nop 0
    buffer_load_dwordx4 v116, s[8:11], s28 offen lds
    s_add_u32 s28, s93, 0
    s_mov_b32 m0, 91136
    s_nop 0
    buffer_load_dwordx4 v117, s[8:11], s28 offen lds
    s_add_u32 s28, s93, 0
    s_mov_b32 m0, 92160
    s_nop 0
    buffer_load_dwordx4 v118, s[8:11], s28 offen lds
    s_add_u32 s28, s93, 0
    s_mov_b32 m0, 93184
    s_nop 0
    buffer_load_dwordx4 v119, s[8:11], s28 offen lds
    s_add_u32 s28, s93, 0
    s_mov_b32 m0, 94208
    s_nop 0
    buffer_load_dwordx4 v120, s[8:11], s28 offen lds
    s_add_u32 s28, s93, 40960
    s_mov_b32 m0, 95232
    s_nop 0
    buffer_load_dwordx4 v116, s[8:11], s28 offen lds
    s_add_u32 s28, s93, 40960
    s_mov_b32 m0, 96256
    s_nop 0
    buffer_load_dwordx4 v117, s[8:11], s28 offen lds
    s_add_u32 s28, s93, 40960
    s_mov_b32 m0, 97280
    s_nop 0
    buffer_load_dwordx4 v118, s[8:11], s28 offen lds
    s_waitcnt vmcnt(0)
    v_mov_b32 v2, 162440
    v_mov_b32 v3, 1
    s_mov_b64 exec, 1
    ds_add_u32 v2, v3
    s_mov_b64 exec, -1
    v_mov_b32 v2, 162416
    s_mov_b32 s43, 0
lw_152:
    ds_read_b32 v3, v2
    s_waitcnt lgkmcnt(0)
    v_readfirstlane_b32 s42, v3
    s_nop 3
    s_cmp_ge_u32 s42, 8
    s_cbranch_scc1 lwd_153
    s_add_u32 s43, s43, 1
    s_cmp_lt_u32 s43, 320000
    s_cbranch_scc0 lwd_153
    s_branch lw_152
lwd_153:
    s_add_u32 s94, s97, 3
    s_sub_u32 s92, s94, 5
    s_cmp_ge_u32 s94, 5
    s_cselect_b32 s94, s92, s94
    s_lshl_b32 s92, s94, 8
    s_mul_i32 s93, s94, 163840
    s_add_u32 s28, s92, 61440
    s_mov_b32 m0, 12288
    s_nop 0
    buffer_load_dwordx4 v112, s[4:7], s28 offen lds
    s_add_u32 s28, s92, 61440
    s_mov_b32 m0, 13312
    s_nop 0
    buffer_load_dwordx4 v113, s[4:7], s28 offen lds
    s_add_u32 s28, s92, 61440
    s_mov_b32 m0, 14336
    s_nop 0
    buffer_load_dwordx4 v114, s[4:7], s28 offen lds
    s_add_u32 s28, s92, 61440
    s_mov_b32 m0, 15360
    s_nop 0
    buffer_load_dwordx4 v115, s[4:7], s28 offen lds
    s_add_u32 s28, s93, 0
    s_mov_b32 m0, 16384
    s_nop 0
    buffer_load_dwordx4 v116, s[8:11], s28 offen lds
    s_add_u32 s28, s93, 0
    s_mov_b32 m0, 17408
    s_nop 0
    buffer_load_dwordx4 v117, s[8:11], s28 offen lds
    s_add_u32 s28, s93, 0
    s_mov_b32 m0, 18432
    s_nop 0
    buffer_load_dwordx4 v118, s[8:11], s28 offen lds
    s_add_u32 s28, s93, 0
    s_mov_b32 m0, 19456
    s_nop 0
    buffer_load_dwordx4 v119, s[8:11], s28 offen lds
    s_add_u32 s28, s93, 0
    s_mov_b32 m0, 20480
    s_nop 0
    buffer_load_dwordx4 v120, s[8:11], s28 offen lds
    s_add_u32 s28, s93, 40960
    s_mov_b32 m0, 21504
    s_nop 0
    buffer_load_dwordx4 v116, s[8:11], s28 offen lds
    s_add_u32 s28, s93, 40960
    s_mov_b32 m0, 22528
    s_nop 0
    buffer_load_dwordx4 v117, s[8:11], s28 offen lds
    s_add_u32 s28, s93, 40960
    s_mov_b32 m0, 23552
    s_nop 0
    buffer_load_dwordx4 v118, s[8:11], s28 offen lds
    v_mov_b32 v2, 162420
    s_mov_b32 s43, 0
lw_154:
    ds_read_b32 v3, v2
    s_waitcnt lgkmcnt(0)
    v_readfirstlane_b32 s42, v3
    s_nop 3
    s_cmp_ge_u32 s42, 8
    s_cbranch_scc1 lwd_155
    s_add_u32 s43, s43, 1
    s_cmp_lt_u32 s43, 320000
    s_cbranch_scc0 lwd_155
    s_branch lw_154
lwd_155:
    s_add_u32 s94, s97, 4
    s_sub_u32 s92, s94, 5
    s_cmp_ge_u32 s94, 5
    s_cselect_b32 s94, s92, s94
    s_lshl_b32 s92, s94, 8
    s_mul_i32 s93, s94, 163840
    s_add_u32 s28, s92, 61440
    s_mov_b32 m0, 49152
    s_nop 0
    buffer_load_dwordx4 v112, s[4:7], s28 offen lds
    s_add_u32 s28, s92, 61440
    s_mov_b32 m0, 50176
    s_nop 0
    buffer_load_dwordx4 v113, s[4:7], s28 offen lds
    s_add_u32 s28, s92, 61440
    s_mov_b32 m0, 51200
    s_nop 0
    buffer_load_dwordx4 v114, s[4:7], s28 offen lds
    s_add_u32 s28, s92, 61440
    s_mov_b32 m0, 52224
    s_nop 0
    buffer_load_dwordx4 v115, s[4:7], s28 offen lds
    s_add_u32 s28, s93, 0
    s_mov_b32 m0, 53248
    s_nop 0
    buffer_load_dwordx4 v116, s[8:11], s28 offen lds
    s_add_u32 s28, s93, 0
    s_mov_b32 m0, 54272
    s_nop 0
    buffer_load_dwordx4 v117, s[8:11], s28 offen lds
    s_add_u32 s28, s93, 0
    s_mov_b32 m0, 55296
    s_nop 0
    buffer_load_dwordx4 v118, s[8:11], s28 offen lds
    s_add_u32 s28, s93, 0
    s_mov_b32 m0, 56320
    s_nop 0
    buffer_load_dwordx4 v119, s[8:11], s28 offen lds
    s_add_u32 s28, s93, 0
    s_mov_b32 m0, 57344
    s_nop 0
    buffer_load_dwordx4 v120, s[8:11], s28 offen lds
    s_add_u32 s28, s93, 40960
    s_mov_b32 m0, 58368
    s_nop 0
    buffer_load_dwordx4 v116, s[8:11], s28 offen lds
    s_add_u32 s28, s93, 40960
    s_mov_b32 m0, 59392
    s_nop 0
    buffer_load_dwordx4 v117, s[8:11], s28 offen lds
    s_add_u32 s28, s93, 40960
    s_mov_b32 m0, 60416
    s_nop 0
    buffer_load_dwordx4 v118, s[8:11], s28 offen lds
    s_waitcnt vmcnt(12)
    v_mov_b32 v2, 162444
    v_mov_b32 v3, 1
    s_mov_b64 exec, 1
    ds_add_u32 v2, v3
    s_mov_b64 exec, -1
    s_waitcnt vmcnt(0)
    v_mov_b32 v2, 162448
    v_mov_b32 v3, 1
    s_mov_b64 exec, 1
    ds_add_u32 v2, v3
    s_mov_b64 exec, -1
    s_branch ldj_145
ldv_151:
    s_cmp_lg_u32 s34, 2
    s_cbranch_scc1 ldv_156
    s_add_u32 s94, s97, 2
    s_sub_u32 s92, s94, 5
    s_cmp_ge_u32 s94, 5
    s_cselect_b32 s94, s92, s94
    s_lshl_b32 s92, s94, 8
    s_mul_i32 s93, s94, 163840
    s_add_u32 s28, s93, 40960
    s_mov_b32 m0, 98304
    s_nop 0
    buffer_load_dwordx4 v119, s[8:11], s28 offen lds
    s_add_u32 s28, s93, 40960
    s_mov_b32 m0, 99328
    s_nop 0
    buffer_load_dwordx4 v120, s[8:11], s28 offen lds
    s_add_u32 s28, s93, 81920
    s_mov_b32 m0, 100352
    s_nop 0
    buffer_load_dwordx4 v116, s[8:11], s28 offen lds
    s_add_u32 s28, s93, 81920
    s_mov_b32 m0, 101376
    s_nop 0
    buffer_load_dwordx4 v117, s[8:11], s28 offen lds
    s_add_u32 s28, s93, 81920
    s_mov_b32 m0, 102400
    s_nop 0
    buffer_load_dwordx4 v118, s[8:11], s28 offen lds
    s_add_u32 s28, s93, 81920
    s_mov_b32 m0, 103424
    s_nop 0
    buffer_load_dwordx4 v119, s[8:11], s28 offen lds
    s_add_u32 s28, s93, 81920
    s_mov_b32 m0, 104448
    s_nop 0
    buffer_load_dwordx4 v120, s[8:11], s28 offen lds
    s_add_u32 s28, s93, 122880
    s_mov_b32 m0, 105472
    s_nop 0
    buffer_load_dwordx4 v116, s[8:11], s28 offen lds
    s_add_u32 s28, s93, 122880
    s_mov_b32 m0, 106496
    s_nop 0
    buffer_load_dwordx4 v117, s[8:11], s28 offen lds
    s_add_u32 s28, s93, 122880
    s_mov_b32 m0, 107520
    s_nop 0
    buffer_load_dwordx4 v118, s[8:11], s28 offen lds
    s_add_u32 s28, s93, 122880
    s_mov_b32 m0, 108544
    s_nop 0
    buffer_load_dwordx4 v119, s[8:11], s28 offen lds
    s_add_u32 s28, s93, 122880
    s_mov_b32 m0, 109568
    s_nop 0
    buffer_load_dwordx4 v120, s[8:11], s28 offen lds
    s_waitcnt vmcnt(0)
    v_mov_b32 v2, 162440
    v_mov_b32 v3, 1
    s_mov_b64 exec, 1
    ds_add_u32 v2, v3
    s_mov_b64 exec, -1
    v_mov_b32 v2, 162416
    s_mov_b32 s43, 0
lw_157:
    ds_read_b32 v3, v2
    s_waitcnt lgkmcnt(0)
    v_readfirstlane_b32 s42, v3
    s_nop 3
    s_cmp_ge_u32 s42, 8
    s_cbranch_scc1 lwd_158
    s_add_u32 s43, s43, 1
    s_cmp_lt_u32 s43, 320000
    s_cbranch_scc0 lwd_158
    s_branch lw_157
lwd_158:
    s_add_u32 s94, s97, 3
    s_sub_u32 s92, s94, 5
    s_cmp_ge_u32 s94, 5
    s_cselect_b32 s94, s92, s94
    s_lshl_b32 s92, s94, 8
    s_mul_i32 s93, s94, 163840
    s_add_u32 s28, s93, 40960
    s_mov_b32 m0, 24576
    s_nop 0
    buffer_load_dwordx4 v119, s[8:11], s28 offen lds
    s_add_u32 s28, s93, 40960
    s_mov_b32 m0, 25600
    s_nop 0
    buffer_load_dwordx4 v120, s[8:11], s28 offen lds
    s_add_u32 s28, s93, 81920
    s_mov_b32 m0, 26624
    s_nop 0
    buffer_load_dwordx4 v116, s[8:11], s28 offen lds
    s_add_u32 s28, s93, 81920
    s_mov_b32 m0, 27648
    s_nop 0
    buffer_load_dwordx4 v117, s[8:11], s28 offen lds
    s_add_u32 s28, s93, 81920
    s_mov_b32 m0, 28672
    s_nop 0
    buffer_load_dwordx4 v118, s[8:11], s28 offen lds
    s_add_u32 s28, s93, 81920
    s_mov_b32 m0, 29696
    s_nop 0
    buffer_load_dwordx4 v119, s[8:11], s28 offen lds
    s_add_u32 s28, s93, 81920
    s_mov_b32 m0, 30720
    s_nop 0
    buffer_load_dwordx4 v120, s[8:11], s28 offen lds
    s_add_u32 s28, s93, 122880
    s_mov_b32 m0, 31744
    s_nop 0
    buffer_load_dwordx4 v116, s[8:11], s28 offen lds
    s_add_u32 s28, s93, 122880
    s_mov_b32 m0, 32768
    s_nop 0
    buffer_load_dwordx4 v117, s[8:11], s28 offen lds
    s_add_u32 s28, s93, 122880
    s_mov_b32 m0, 33792
    s_nop 0
    buffer_load_dwordx4 v118, s[8:11], s28 offen lds
    s_add_u32 s28, s93, 122880
    s_mov_b32 m0, 34816
    s_nop 0
    buffer_load_dwordx4 v119, s[8:11], s28 offen lds
    s_add_u32 s28, s93, 122880
    s_mov_b32 m0, 35840
    s_nop 0
    buffer_load_dwordx4 v120, s[8:11], s28 offen lds
    v_mov_b32 v2, 162420
    s_mov_b32 s43, 0
lw_159:
    ds_read_b32 v3, v2
    s_waitcnt lgkmcnt(0)
    v_readfirstlane_b32 s42, v3
    s_nop 3
    s_cmp_ge_u32 s42, 8
    s_cbranch_scc1 lwd_160
    s_add_u32 s43, s43, 1
    s_cmp_lt_u32 s43, 320000
    s_cbranch_scc0 lwd_160
    s_branch lw_159
lwd_160:
    s_add_u32 s94, s97, 4
    s_sub_u32 s92, s94, 5
    s_cmp_ge_u32 s94, 5
    s_cselect_b32 s94, s92, s94
    s_lshl_b32 s92, s94, 8
    s_mul_i32 s93, s94, 163840
    s_add_u32 s28, s93, 40960
    s_mov_b32 m0, 61440
    s_nop 0
    buffer_load_dwordx4 v119, s[8:11], s28 offen lds
    s_add_u32 s28, s93, 40960
    s_mov_b32 m0, 62464
    s_nop 0
    buffer_load_dwordx4 v120, s[8:11], s28 offen lds
    s_add_u32 s28, s93, 81920
    s_mov_b32 m0, 63488
    s_nop 0
    buffer_load_dwordx4 v116, s[8:11], s28 offen lds
    s_add_u32 s28, s93, 81920
    s_mov_b32 m0, 64512
    s_nop 0
    buffer_load_dwordx4 v117, s[8:11], s28 offen lds
    s_add_u32 s28, s93, 81920
    s_mov_b32 m0, 65536
    s_nop 0
    buffer_load_dwordx4 v118, s[8:11], s28 offen lds
    s_add_u32 s28, s93, 81920
    s_mov_b32 m0, 66560
    s_nop 0
    buffer_load_dwordx4 v119, s[8:11], s28 offen lds
    s_add_u32 s28, s93, 81920
    s_mov_b32 m0, 67584
    s_nop 0
    buffer_load_dwordx4 v120, s[8:11], s28 offen lds
    s_add_u32 s28, s93, 122880
    s_mov_b32 m0, 68608
    s_nop 0
    buffer_load_dwordx4 v116, s[8:11], s28 offen lds
    s_add_u32 s28, s93, 122880
    s_mov_b32 m0, 69632
    s_nop 0
    buffer_load_dwordx4 v117, s[8:11], s28 offen lds
    s_add_u32 s28, s93, 122880
    s_mov_b32 m0, 70656
    s_nop 0
    buffer_load_dwordx4 v118, s[8:11], s28 offen lds
    s_add_u32 s28, s93, 122880
    s_mov_b32 m0, 71680
    s_nop 0
    buffer_load_dwordx4 v119, s[8:11], s28 offen lds
    s_add_u32 s28, s93, 122880
    s_mov_b32 m0, 72704
    s_nop 0
    buffer_load_dwordx4 v120, s[8:11], s28 offen lds
    s_waitcnt vmcnt(12)
    v_mov_b32 v2, 162444
    v_mov_b32 v3, 1
    s_mov_b64 exec, 1
    ds_add_u32 v2, v3
    s_mov_b64 exec, -1
    s_waitcnt vmcnt(0)
    v_mov_b32 v2, 162448
    v_mov_b32 v3, 1
    s_mov_b64 exec, 1
    ds_add_u32 v2, v3
    s_mov_b64 exec, -1
    s_branch ldj_145
ldv_156:
ldj_145:
    s_cmp_lg_u32 s34, 2
    s_cbranch_scc1 ifw_161
    v_mov_b32 v2, 162424
    s_mov_b32 s43, 0
lw_162:
    ds_read_b32 v3, v2
    s_waitcnt lgkmcnt(0)
    v_readfirstlane_b32 s42, v3
    s_nop 3
    s_cmp_ge_u32 s42, 8
    s_cbranch_scc1 lwd_163
    s_add_u32 s43, s43, 1
    s_cmp_lt_u32 s43, 320000
    s_cbranch_scc0 lwd_163
    s_sleep 1
    s_branch lw_162
lwd_163:
    v_lshrrev_b32 v2, 5, v1
    v_lshlrev_b32 v2, 9, v2
    v_and_b32 v3, 31, v1
    v_lshlrev_b32 v3, 2, v3
    v_add_u32 v2, v2, v3
    v_add_u32 v2, 161024, v2
    ds_read_b32 v96, v2 offset:0
    ds_read_b32 v97, v2 offset:128
    ds_read_b32 v98, v2 offset:256
    ds_read_b32 v99, v2 offset:384
    s_waitcnt lgkmcnt(0)
    v_add_f32 v96, v96, v97
    v_add_f32 v98, v98, v99
    v_add_f32 v96, v96, v98
    v_mul_f32 v96, 0xbfb8aa3b, v96
    v_exp_f32 v96, v96
    s_nop 0
    v_add_f32 v96, 1.0, v96
    v_rcp_f32 v96, v96
    v_lshlrev_b32 v2, 2, v1
    v_add_u32 v2, 162048, v2
    s_nop 0
    ds_write_b32 v2, v96
ifw_161:
    v_mov_b32 v2, 162404
    s_mov_b32 s43, 0
lw_164:
    ds_read_b32 v3, v2
    s_waitcnt lgkmcnt(0)
    v_readfirstlane_b32 s42, v3
    s_nop 3
    s_cmp_ge_u32 s42, 1
    s_cbranch_scc1 lwd_165
    s_add_u32 s43, s43, 1
    s_cmp_lt_u32 s43, 320000
    s_cbranch_scc0 lwd_165
    s_sleep 1
    s_branch lw_164
lwd_165:
    s_mov_b32 s87, s34
    s_lshl_b32 s28, s87, 6
    v_add_u32 v2, s28, v1
    v_lshrrev_b32 v3, 3, v2
    v_and_b32 v2, 7, v2
    s_mul_i32 s29, s21, 160
    v_lshlrev_b32 v164, 2, v3
    v_add_u32 v164, s29, v164
    v_lshlrev_b32 v95, 2, v164
    buffer_load_dwordx4 v[36:39], v95, s[52:55], 0 offen
    v_lshlrev_b32 v95, 11, v164
    v_lshlrev_b32 v164, 4, v2
    v_sub_u32 v95, v95, v164
    s_lshl_b32 s29, s20, 7
    s_sub_u32 s29, 266224, s29
    v_add_u32 v95, s29, v95
    v_lshrrev_b32 v164, 2, v3
    v_add_u32 v164, v164, v2
    v_and_b32 v3, 3, v3
    v_lshlrev_b32 v3, 2, v3
    v_mul_u32_u24 v2, 1280, v2
    v_add_u32 v2, v2, v3
    v_add_u32 v2, 137472, v2
    v_add_u32 v92, 0, v164
    v_subrev_u32 v3, 10, v92
    v_min_u32 v92, v92, v3
    v_lshlrev_b32 v92, 4, v92
    v_add_u32 v93, v2, v92
    v_add_u32 v92, 1, v164
    v_subrev_u32 v3, 10, v92
    v_min_u32 v92, v92, v3
    v_lshlrev_b32 v92, 4, v92
    v_add_u32 v94, v2, v92
    ds_read_b32 v16, v93 offset:0
    ds_read_b32 v17, v93 offset:160
    ds_read_b32 v18, v93 offset:320
    ds_read_b32 v19, v93 offset:480
    ds_read_b32 v20, v93 offset:640
    ds_read_b32 v21, v93 offset:800
    ds_read_b32 v22, v93 offset:960
    ds_read_b32 v23, v93 offset:1120
    ds_read_b32 v24, v94 offset:1280
    ds_read_b32 v25, v94 offset:1440
    ds_read_b32 v26, v94 offset:1600
    s_waitcnt lgkmcnt(4)
    ds_read_b32 v28, v93 offset:10720
    ds_read_b32 v29, v93 offset:10880
    ds_read_b32 v30, v93 offset:11040
    ds_read_b32 v31, v93 offset:11200
    ds_read_b32 v32, v93 offset:11360
    ds_read_b32 v33, v93 offset:11520
    ds_read_b32 v34, v93 offset:11680
    ds_read_b32 v35, v93 offset:11840
    s_waitcnt lgkmcnt(0) vmcnt(0)
    v_lshlrev_b32 v44, 16, v16
    v_and_b32 v56, 0xffff0000, v16
    v_lshlrev_b32 v45, 16, v17
    v_and_b32 v57, 0xffff0000, v17
    v_lshlrev_b32 v46, 16, v18
    v_and_b32 v58, 0xffff0000, v18
    v_lshlrev_b32 v47, 16, v19
    v_and_b32 v59, 0xffff0000, v19
    v_lshlrev_b32 v48, 16, v20
    v_and_b32 v60, 0xffff0000, v20
    v_lshlrev_b32 v49, 16, v21
    v_and_b32 v61, 0xffff0000, v21
    v_lshlrev_b32 v50, 16, v22
    v_and_b32 v62, 0xffff0000, v22
    v_lshlrev_b32 v51, 16, v23
    v_and_b32 v63, 0xffff0000, v23
    v_lshlrev_b32 v52, 16, v24
    v_and_b32 v64, 0xffff0000, v24
    v_lshlrev_b32 v53, 16, v25
    v_and_b32 v65, 0xffff0000, v25
    v_lshlrev_b32 v54, 16, v26
    v_and_b32 v66, 0xffff0000, v26
    v_lshlrev_b32 v68, 16, v36
    v_and_b32 v69, 0xffff0000, v36
    v_lshlrev_b32 v70, 16, v37
    v_and_b32 v71, 0xffff0000, v37
    v_lshlrev_b32 v72, 16, v38
    v_and_b32 v73, 0xffff0000, v38
    v_lshlrev_b32 v74, 16, v39
    v_and_b32 v75, 0xffff0000, v39
    v_mul_f32 v76, v47, v68
    v_fmac_f32 v76, v46, v69
    v_fmac_f32 v76, v45, v70
    v_fmac_f32 v76, v44, v71
    v_lshlrev_b32 v92, 16, v28
    v_mul_f32 v76, v76, v92
    v_mul_f32 v84, v59, v72
    v_fmac_f32 v84, v58, v73
    v_fmac_f32 v84, v57, v74
    v_fmac_f32 v84, v56, v75
    v_and_b32 v92, 0xffff0000, v28
    v_mul_f32 v84, v84, v92
    v_mul_f32 v77, v48, v68
    v_fmac_f32 v77, v47, v69
    v_fmac_f32 v77, v46, v70
    v_fmac_f32 v77, v45, v71
    v_lshlrev_b32 v92, 16, v29
    v_mul_f32 v77, v77, v92
    v_mul_f32 v85, v60, v72
    v_fmac_f32 v85, v59, v73
    v_fmac_f32 v85, v58, v74
    v_fmac_f32 v85, v57, v75
    v_and_b32 v92, 0xffff0000, v29
    v_mul_f32 v85, v85, v92
    v_mul_f32 v78, v49, v68
    v_fmac_f32 v78, v48, v69
    v_fmac_f32 v78, v47, v70
    v_fmac_f32 v78, v46, v71
    v_lshlrev_b32 v92, 16, v30
    v_mul_f32 v78, v78, v92
    v_mul_f32 v86, v61, v72
    v_fmac_f32 v86, v60, v73
    v_fmac_f32 v86, v59, v74
    v_fmac_f32 v86, v58, v75
    v_and_b32 v92, 0xffff0000, v30
    v_mul_f32 v86, v86, v92
    v_mul_f32 v79, v50, v68
    v_fmac_f32 v79, v49, v69
    v_fmac_f32 v79, v48, v70
    v_fmac_f32 v79, v47, v71
    v_lshlrev_b32 v92, 16, v31
    v_mul_f32 v79, v79, v92
    v_mul_f32 v87, v62, v72
    v_fmac_f32 v87, v61, v73
    v_fmac_f32 v87, v60, v74
    v_fmac_f32 v87, v59, v75
    v_and_b32 v92, 0xffff0000, v31
    v_mul_f32 v87, v87, v92
    v_mul_f32 v80, v51, v68
    v_fmac_f32 v80, v50, v69
    v_fmac_f32 v80, v49, v70
    v_fmac_f32 v80, v48, v71
    v_lshlrev_b32 v92, 16, v32
    v_mul_f32 v80, v80, v92
    v_mul_f32 v88, v63, v72
    v_fmac_f32 v88, v62, v73
    v_fmac_f32 v88, v61, v74
    v_fmac_f32 v88, v60, v75
    v_and_b32 v92, 0xffff0000, v32
    v_mul_f32 v88, v88, v92
    v_mul_f32 v81, v52, v68
    v_fmac_f32 v81, v51, v69
    v_fmac_f32 v81, v50, v70
    v_fmac_f32 v81, v49, v71
    v_lshlrev_b32 v92, 16, v33
    v_mul_f32 v81, v81, v92
    v_mul_f32 v89, v64, v72
    v_fmac_f32 v89, v63, v73
    v_fmac_f32 v89, v62, v74
    v_fmac_f32 v89, v61, v75
    v_and_b32 v92, 0xffff0000, v33
    v_mul_f32 v89, v89, v92
    v_mul_f32 v82, v53, v68
    v_fmac_f32 v82, v52, v69
    v_fmac_f32 v82, v51, v70
    v_fmac_f32 v82, v50, v71
    v_lshlrev_b32 v92, 16, v34
    v_mul_f32 v82, v82, v92
    v_mul_f32 v90, v65, v72
    v_fmac_f32 v90, v64, v73
    v_fmac_f32 v90, v63, v74
    v_fmac_f32 v90, v62, v75
    v_and_b32 v92, 0xffff0000, v34
    v_mul_f32 v90, v90, v92
    v_mul_f32 v83, v54, v68
    v_fmac_f32 v83, v53, v69
    v_fmac_f32 v83, v52, v70
    v_fmac_f32 v83, v51, v71
    v_lshlrev_b32 v92, 16, v35
    v_mul_f32 v83, v83, v92
    v_mul_f32 v91, v66, v72
    v_fmac_f32 v91, v65, v73
    v_fmac_f32 v91, v64, v74
    v_fmac_f32 v91, v63, v75
    v_and_b32 v92, 0xffff0000, v35
    v_mul_f32 v91, v91, v92
    v_cvt_pk_bf16_f32 v16, v83, v82
    v_cvt_pk_bf16_f32 v17, v81, v80
    v_cvt_pk_bf16_f32 v18, v79, v78
    v_cvt_pk_bf16_f32 v19, v77, v76
    v_cvt_pk_bf16_f32 v20, v91, v90
    v_cvt_pk_bf16_f32 v21, v89, v88
    v_cvt_pk_bf16_f32 v22, v87, v86
    v_cvt_pk_bf16_f32 v23, v85, v84
    buffer_store_dwordx4 v[16:19], v95, s[12:15], 0 offen sc1
    v_add_u32 v95, 4096, v95
    buffer_store_dwordx4 v[20:23], v95, s[12:15], 0 offen sc1
    s_cmp_ge_u32 s34, 2
    s_cbranch_scc1 ifw_166
    s_add_u32 s87, s34, 3
    s_lshl_b32 s28, s87, 6
    v_add_u32 v2, s28, v1
    v_lshrrev_b32 v3, 3, v2
    v_and_b32 v2, 7, v2
    s_mul_i32 s29, s21, 160
    v_lshlrev_b32 v164, 2, v3
    v_add_u32 v164, s29, v164
    v_lshlrev_b32 v95, 2, v164
    buffer_load_dwordx4 v[36:39], v95, s[52:55], 0 offen
    v_lshlrev_b32 v95, 11, v164
    v_lshlrev_b32 v164, 4, v2
    v_sub_u32 v95, v95, v164
    s_lshl_b32 s29, s20, 7
    s_sub_u32 s29, 266224, s29
    v_add_u32 v95, s29, v95
    v_lshrrev_b32 v164, 2, v3
    v_add_u32 v164, v164, v2
    v_and_b32 v3, 3, v3
    v_lshlrev_b32 v3, 2, v3
    v_mul_u32_u24 v2, 1280, v2
    v_add_u32 v2, v2, v3
    v_add_u32 v2, 137472, v2
    v_add_u32 v92, 0, v164
    v_subrev_u32 v3, 10, v92
    v_min_u32 v92, v92, v3
    v_lshlrev_b32 v92, 4, v92
    v_add_u32 v93, v2, v92
    v_add_u32 v92, 1, v164
    v_subrev_u32 v3, 10, v92
    v_min_u32 v92, v92, v3
    v_lshlrev_b32 v92, 4, v92
    v_add_u32 v94, v2, v92
    ds_read_b32 v16, v93 offset:0
    ds_read_b32 v17, v93 offset:160
    ds_read_b32 v18, v93 offset:320
    ds_read_b32 v19, v93 offset:480
    ds_read_b32 v20, v93 offset:640
    ds_read_b32 v21, v93 offset:800
    ds_read_b32 v22, v93 offset:960
    ds_read_b32 v23, v93 offset:1120
    ds_read_b32 v24, v94 offset:1280
    ds_read_b32 v25, v94 offset:1440
    ds_read_b32 v26, v94 offset:1600
    s_waitcnt lgkmcnt(4)
    ds_read_b32 v28, v93 offset:10720
    ds_read_b32 v29, v93 offset:10880
    ds_read_b32 v30, v93 offset:11040
    ds_read_b32 v31, v93 offset:11200
    ds_read_b32 v32, v93 offset:11360
    ds_read_b32 v33, v93 offset:11520
    ds_read_b32 v34, v93 offset:11680
    ds_read_b32 v35, v93 offset:11840
    s_waitcnt lgkmcnt(0) vmcnt(0)
    v_lshlrev_b32 v44, 16, v16
    v_and_b32 v56, 0xffff0000, v16
    v_lshlrev_b32 v45, 16, v17
    v_and_b32 v57, 0xffff0000, v17
    v_lshlrev_b32 v46, 16, v18
    v_and_b32 v58, 0xffff0000, v18
    v_lshlrev_b32 v47, 16, v19
    v_and_b32 v59, 0xffff0000, v19
    v_lshlrev_b32 v48, 16, v20
    v_and_b32 v60, 0xffff0000, v20
    v_lshlrev_b32 v49, 16, v21
    v_and_b32 v61, 0xffff0000, v21
    v_lshlrev_b32 v50, 16, v22
    v_and_b32 v62, 0xffff0000, v22
    v_lshlrev_b32 v51, 16, v23
    v_and_b32 v63, 0xffff0000, v23
    v_lshlrev_b32 v52, 16, v24
    v_and_b32 v64, 0xffff0000, v24
    v_lshlrev_b32 v53, 16, v25
    v_and_b32 v65, 0xffff0000, v25
    v_lshlrev_b32 v54, 16, v26
    v_and_b32 v66, 0xffff0000, v26
    v_lshlrev_b32 v68, 16, v36
    v_and_b32 v69, 0xffff0000, v36
    v_lshlrev_b32 v70, 16, v37
    v_and_b32 v71, 0xffff0000, v37
    v_lshlrev_b32 v72, 16, v38
    v_and_b32 v73, 0xffff0000, v38
    v_lshlrev_b32 v74, 16, v39
    v_and_b32 v75, 0xffff0000, v39
    v_mul_f32 v76, v47, v68
    v_fmac_f32 v76, v46, v69
    v_fmac_f32 v76, v45, v70
    v_fmac_f32 v76, v44, v71
    v_lshlrev_b32 v92, 16, v28
    v_mul_f32 v76, v76, v92
    v_mul_f32 v84, v59, v72
    v_fmac_f32 v84, v58, v73
    v_fmac_f32 v84, v57, v74
    v_fmac_f32 v84, v56, v75
    v_and_b32 v92, 0xffff0000, v28
    v_mul_f32 v84, v84, v92
    v_mul_f32 v77, v48, v68
    v_fmac_f32 v77, v47, v69
    v_fmac_f32 v77, v46, v70
    v_fmac_f32 v77, v45, v71
    v_lshlrev_b32 v92, 16, v29
    v_mul_f32 v77, v77, v92
    v_mul_f32 v85, v60, v72
    v_fmac_f32 v85, v59, v73
    v_fmac_f32 v85, v58, v74
    v_fmac_f32 v85, v57, v75
    v_and_b32 v92, 0xffff0000, v29
    v_mul_f32 v85, v85, v92
    v_mul_f32 v78, v49, v68
    v_fmac_f32 v78, v48, v69
    v_fmac_f32 v78, v47, v70
    v_fmac_f32 v78, v46, v71
    v_lshlrev_b32 v92, 16, v30
    v_mul_f32 v78, v78, v92
    v_mul_f32 v86, v61, v72
    v_fmac_f32 v86, v60, v73
    v_fmac_f32 v86, v59, v74
    v_fmac_f32 v86, v58, v75
    v_and_b32 v92, 0xffff0000, v30
    v_mul_f32 v86, v86, v92
    v_mul_f32 v79, v50, v68
    v_fmac_f32 v79, v49, v69
    v_fmac_f32 v79, v48, v70
    v_fmac_f32 v79, v47, v71
    v_lshlrev_b32 v92, 16, v31
    v_mul_f32 v79, v79, v92
    v_mul_f32 v87, v62, v72
    v_fmac_f32 v87, v61, v73
    v_fmac_f32 v87, v60, v74
    v_fmac_f32 v87, v59, v75
    v_and_b32 v92, 0xffff0000, v31
    v_mul_f32 v87, v87, v92
    v_mul_f32 v80, v51, v68
    v_fmac_f32 v80, v50, v69
    v_fmac_f32 v80, v49, v70
    v_fmac_f32 v80, v48, v71
    v_lshlrev_b32 v92, 16, v32
    v_mul_f32 v80, v80, v92
    v_mul_f32 v88, v63, v72
    v_fmac_f32 v88, v62, v73
    v_fmac_f32 v88, v61, v74
    v_fmac_f32 v88, v60, v75
    v_and_b32 v92, 0xffff0000, v32
    v_mul_f32 v88, v88, v92
    v_mul_f32 v81, v52, v68
    v_fmac_f32 v81, v51, v69
    v_fmac_f32 v81, v50, v70
    v_fmac_f32 v81, v49, v71
    v_lshlrev_b32 v92, 16, v33
    v_mul_f32 v81, v81, v92
    v_mul_f32 v89, v64, v72
    v_fmac_f32 v89, v63, v73
    v_fmac_f32 v89, v62, v74
    v_fmac_f32 v89, v61, v75
    v_and_b32 v92, 0xffff0000, v33
    v_mul_f32 v89, v89, v92
    v_mul_f32 v82, v53, v68
    v_fmac_f32 v82, v52, v69
    v_fmac_f32 v82, v51, v70
    v_fmac_f32 v82, v50, v71
    v_lshlrev_b32 v92, 16, v34
    v_mul_f32 v82, v82, v92
    v_mul_f32 v90, v65, v72
    v_fmac_f32 v90, v64, v73
    v_fmac_f32 v90, v63, v74
    v_fmac_f32 v90, v62, v75
    v_and_b32 v92, 0xffff0000, v34
    v_mul_f32 v90, v90, v92
    v_mul_f32 v83, v54, v68
    v_fmac_f32 v83, v53, v69
    v_fmac_f32 v83, v52, v70
    v_fmac_f32 v83, v51, v71
    v_lshlrev_b32 v92, 16, v35
    v_mul_f32 v83, v83, v92
    v_mul_f32 v91, v66, v72
    v_fmac_f32 v91, v65, v73
    v_fmac_f32 v91, v64, v74
    v_fmac_f32 v91, v63, v75
    v_and_b32 v92, 0xffff0000, v35
    v_mul_f32 v91, v91, v92
    v_cvt_pk_bf16_f32 v16, v83, v82
    v_cvt_pk_bf16_f32 v17, v81, v80
    v_cvt_pk_bf16_f32 v18, v79, v78
    v_cvt_pk_bf16_f32 v19, v77, v76
    v_cvt_pk_bf16_f32 v20, v91, v90
    v_cvt_pk_bf16_f32 v21, v89, v88
    v_cvt_pk_bf16_f32 v22, v87, v86
    v_cvt_pk_bf16_f32 v23, v85, v84
    buffer_store_dwordx4 v[16:19], v95, s[12:15], 0 offen sc1
    v_add_u32 v95, 4096, v95
    buffer_store_dwordx4 v[20:23], v95, s[12:15], 0 offen sc1
ifw_166:
    s_waitcnt vmcnt(0)
    s_setprio 3
    v_mov_b32 v2, 162376
    v_mov_b32 v3, 1
    s_mov_b64 exec, 1
    ds_add_u32 v2, v3
    s_mov_b64 exec, -1
    s_cmp_lg_u32 s34, 2
    s_cbranch_scc1 ifw_167
    v_mov_b32 v2, 162368
    s_mov_b32 s43, 0
lw_168:
    ds_read_b32 v3, v2
    s_waitcnt lgkmcnt(0)
    v_readfirstlane_b32 s42, v3
    s_nop 3
    s_cmp_ge_u32 s42, 1
    s_cbranch_scc1 lwd_169
    s_add_u32 s43, s43, 1
    s_cmp_lt_u32 s43, 320000
    s_cbranch_scc0 lwd_169
    s_sleep 1
    s_branch lw_168
lwd_169:
    s_mov_b32 s25, s42
    s_lshl_b32 s89, s20, 3
    s_add_u32 s89, s89, s21
    s_lshl_b32 s89, s89, 7
    s_lshl_b32 s90, s21, 7
    s_lshl_b32 s28, s20, 2
    s_add_u32 s90, s90, s28
    v_mov_b32 v2, 162376
    s_mov_b32 s43, 0
lw_170:
    ds_read_b32 v3, v2
    s_waitcnt lgkmcnt(0)
    v_readfirstlane_b32 s42, v3
    s_nop 3
    s_cmp_ge_u32 s42, 3
    s_cbranch_scc1 lwd_171
    s_add_u32 s43, s43, 1
    s_cmp_lt_u32 s43, 320000
    s_cbranch_scc0 lwd_171
    s_sleep 1
    s_branch lw_170
lwd_171:
    s_add_u32 s29, s90, 8142848
    v_lshlrev_b32 v2, 10, v1
    v_mov_b32 v3, s25
    s_mov_b64 exec, 0xffffffff
    buffer_store_dword v3, v2, s[12:15], s29 offen sc1
    s_mov_b64 exec, -1
ifw_167:
    v_lshlrev_b32 v121, 4, v1
    s_mul_i32 s29, s21, 160
    v_add_u32 v2, 0, v1
    v_mul_u32_u24 v3, 6554, v2
    v_lshrrev_b32 v3, 16, v3
    v_mul_u32_u24 v164, 10, v3
    v_sub_u32 v2, v2, v164
    v_lshlrev_b32 v2, 4, v2
    v_and_b32 v164, 0xfff3, v3
    v_bfe_u32 v165, v3, 2, 1
    v_lshlrev_b32 v165, 3, v165
    v_or_b32 v164, v164, v165
    v_bfe_u32 v165, v3, 3, 1
    v_lshlrev_b32 v165, 2, v165
    v_or_b32 v164, v164, v165
    v_mul_lo_u32 v164, v164, s26
    v_add_u32 v164, v164, v2
    v_add_u32 v116, s29, v164
    v_add_u32 v2, 64, v1
    v_mul_u32_u24 v3, 6554, v2
    v_lshrrev_b32 v3, 16, v3
    v_mul_u32_u24 v164, 10, v3
    v_sub_u32 v2, v2, v164
    v_lshlrev_b32 v2, 4, v2
    v_and_b32 v164, 0xfff3, v3
    v_bfe_u32 v165, v3, 2, 1
    v_lshlrev_b32 v165, 3, v165
    v_or_b32 v164, v164, v165
    v_bfe_u32 v165, v3, 3, 1
    v_lshlrev_b32 v165, 2, v165
    v_or_b32 v164, v164, v165
    v_mul_lo_u32 v164, v164, s26
    v_add_u32 v164, v164, v2
    v_add_u32 v117, s29, v164
    v_add_u32 v2, 128, v1
    v_mul_u32_u24 v3, 6554, v2
    v_lshrrev_b32 v3, 16, v3
    v_mul_u32_u24 v164, 10, v3
    v_sub_u32 v2, v2, v164
    v_lshlrev_b32 v2, 4, v2
    v_and_b32 v164, 0xfff3, v3
    v_bfe_u32 v165, v3, 2, 1
    v_lshlrev_b32 v165, 3, v165
    v_or_b32 v164, v164, v165
    v_bfe_u32 v165, v3, 3, 1
    v_lshlrev_b32 v165, 2, v165
    v_or_b32 v164, v164, v165
    v_mul_lo_u32 v164, v164, s26
    v_add_u32 v164, v164, v2
    v_add_u32 v118, s29, v164
    v_add_u32 v2, 192, v1
    v_mul_u32_u24 v3, 6554, v2
    v_lshrrev_b32 v3, 16, v3
    v_mul_u32_u24 v164, 10, v3
    v_sub_u32 v2, v2, v164
    v_lshlrev_b32 v2, 4, v2
    v_and_b32 v164, 0xfff3, v3
    v_bfe_u32 v165, v3, 2, 1
    v_lshlrev_b32 v165, 3, v165
    v_or_b32 v164, v164, v165
    v_bfe_u32 v165, v3, 3, 1
    v_lshlrev_b32 v165, 2, v165
    v_or_b32 v164, v164, v165
    v_mul_lo_u32 v164, v164, s26
    v_add_u32 v164, v164, v2
    v_add_u32 v119, s29, v164
    v_add_u32 v2, 256, v1
    v_mul_u32_u24 v3, 6554, v2
    v_lshrrev_b32 v3, 16, v3
    v_mul_u32_u24 v164, 10, v3
    v_sub_u32 v2, v2, v164
    v_lshlrev_b32 v2, 4, v2
    v_and_b32 v164, 0xfff3, v3
    v_bfe_u32 v165, v3, 2, 1
    v_lshlrev_b32 v165, 3, v165
    v_or_b32 v164, v164, v165
    v_bfe_u32 v165, v3, 3, 1
    v_lshlrev_b32 v165, 2, v165
    v_or_b32 v164, v164, v165
    v_mul_lo_u32 v164, v164, s26
    v_add_u32 v164, v164, v2
    v_add_u32 v120, s29, v164
    v_mov_b32 v2, 162376
    s_mov_b32 s43, 0
lw_172:
    ds_read_b32 v3, v2
    s_waitcnt lgkmcnt(0)
    v_readfirstlane_b32 s42, v3
    s_nop 3
    s_cmp_ge_u32 s42, 3
    s_cbranch_scc1 lwd_173
    s_add_u32 s43, s43, 1
    s_cmp_lt_u32 s43, 320000
    s_cbranch_scc0 lwd_173
    s_sleep 1
    s_branch lw_172
lwd_173:
    v_mov_b32 v2, 162424
    s_mov_b32 s43, 0
lw_174:
    ds_read_b32 v3, v2
    s_waitcnt lgkmcnt(0)
    v_readfirstlane_b32 s42, v3
    s_nop 3
    s_cmp_ge_u32 s42, 8
    s_cbranch_scc1 lwd_175
    s_add_u32 s43, s43, 1
    s_cmp_lt_u32 s43, 320000
    s_cbranch_scc0 lwd_175
    s_sleep 1
    s_branch lw_174
lwd_175:
    s_add_u32 s31, s34, 11
wol_176:
    s_cmp_ge_u32 s31, 20
    s_cbranch_scc1 woe_177
    s_mul_i32 s28, s31, 5120
    s_add_u32 s28, s28, 56576
    s_mul_i32 s30, s31, 40960
    s_add_u32 m0, s28, 0
    s_nop 0
    buffer_load_dwordx4 v116, s[64:67], s30 offen lds
    s_add_u32 m0, s28, 1024
    s_nop 0
    buffer_load_dwordx4 v117, s[64:67], s30 offen lds
    s_add_u32 m0, s28, 2048
    s_nop 0
    buffer_load_dwordx4 v118, s[64:67], s30 offen lds
    s_add_u32 m0, s28, 3072
    s_nop 0
    buffer_load_dwordx4 v119, s[64:67], s30 offen lds
    s_add_u32 m0, s28, 4096
    s_nop 0
    buffer_load_dwordx4 v120, s[64:67], s30 offen lds
    s_add_u32 s31, s31, 3
    s_branch wol_176
woe_177:
    v_lshlrev_b32 v165, 4, v1
    s_cmp_lg_u32 s34, 2
    s_cbranch_scc1 ifw_178
    v_lshlrev_b32 v98, 2, v1
    s_add_u32 s29, s89, 8142848
    s_mov_b32 s40, 4294967295
    s_mov_b32 s41, 0
    s_mov_b32 s43, 0
poll_179:
    buffer_load_dword v99, v98, s[12:15], s29 offen sc1
    s_waitcnt vmcnt(0)
    v_cmp_ne_u32 vcc, s25, v99
    s_nop 1
    s_and_b64 vcc, vcc, s[40:41]
    s_cmp_eq_u64 vcc, 0
    s_cbranch_scc1 pdone_180
    s_add_u32 s43, s43, 1
    s_cmp_lt_u32 s43, 40000
    s_cbranch_scc0 pdone_180
    s_sleep 1
    s_branch poll_179
pdone_180:
    v_mov_b32 v2, 162388
    v_mov_b32 v3, 1
    ds_write_b32 v2, v3
ifw_178:
    s_cmp_ge_u32 s34, s84
    s_cbranch_scc1 noconv_181
    s_lshl_b32 s28, s83, 12
    s_add_u32 s29, s28, 0
    buffer_load_dwordx4 v[112:115], v165, s[16:19], s29 offen offset:0
    buffer_load_dwordx4 v[116:119], v165, s[16:19], s29 offen offset:4
    buffer_load_dwordx4 v[120:123], v165, s[16:19], s29 offen offset:8
    s_add_u32 s29, s28, 1024
    buffer_load_dwordx4 v[124:127], v165, s[16:19], s29 offen offset:0
    buffer_load_dwordx4 v[128:131], v165, s[16:19], s29 offen offset:4
    buffer_load_dwordx4 v[132:135], v165, s[16:19], s29 offen offset:8
    s_add_u32 s29, s28, 2048
    buffer_load_dwordx4 v[136:139], v165, s[16:19], s29 offen offset:0
    buffer_load_dwordx4 v[140:143], v165, s[16:19], s29 offen offset:4
    buffer_load_dwordx4 v[144:147], v165, s[16:19], s29 offen offset:8
    s_add_u32 s29, s28, 3072
    buffer_load_dwordx4 v[148:151], v165, s[16:19], s29 offen offset:0
    buffer_load_dwordx4 v[152:155], v165, s[16:19], s29 offen offset:4
    buffer_load_dwordx4 v[156:159], v165, s[16:19], s29 offen offset:8
    s_lshr_b32 s30, s83, 1
    s_lshl_b32 s30, s30, 2
    s_load_dword s88, s[76:77], s30
    v_mov_b32 v2, 162424
    s_mov_b32 s43, 0
lw_182:
    ds_read_b32 v3, v2
    s_waitcnt lgkmcnt(0)
    v_readfirstlane_b32 s42, v3
    s_nop 3
    s_cmp_ge_u32 s42, 8
    s_cbranch_scc1 lwd_183
    s_add_u32 s43, s43, 1
    s_cmp_lt_u32 s43, 320000
    s_cbranch_scc0 lwd_183
    s_sleep 2
    s_branch lw_182
lwd_183:
    v_lshlrev_b32 v164, 4, v1
    v_add_u32 v165, s85, v164
    s_waitcnt vmcnt(0)
    v_alignbit_b32 v16, v116, v112, 16
    v_alignbit_b32 v20, v120, v116, 16
    v_alignbit_b32 v17, v117, v113, 16
    v_alignbit_b32 v21, v121, v117, 16
    v_alignbit_b32 v18, v118, v114, 16
    v_alignbit_b32 v22, v122, v118, 16
    v_alignbit_b32 v19, v119, v115, 16
    v_alignbit_b32 v23, v123, v119, 16
    ds_write_b128 v165, v[112:115] offset:32
    ds_write_b128 v165, v[16:19] offset:4192
    ds_write_b128 v165, v[116:119] offset:8352
    ds_write_b128 v165, v[20:23] offset:12512
    v_alignbit_b32 v24, v128, v124, 16
    v_alignbit_b32 v28, v132, v128, 16
    v_alignbit_b32 v25, v129, v125, 16
    v_alignbit_b32 v29, v133, v129, 16
    v_alignbit_b32 v26, v130, v126, 16
    v_alignbit_b32 v30, v134, v130, 16
    v_alignbit_b32 v27, v131, v127, 16
    v_alignbit_b32 v31, v135, v131, 16
    ds_write_b128 v165, v[124:127] offset:1056
    ds_write_b128 v165, v[24:27] offset:5216
    ds_write_b128 v165, v[128:131] offset:9376
    ds_write_b128 v165, v[28:31] offset:13536
    v_alignbit_b32 v16, v140, v136, 16
    v_alignbit_b32 v20, v144, v140, 16
    v_alignbit_b32 v17, v141, v137, 16
    v_alignbit_b32 v21, v145, v141, 16
    v_alignbit_b32 v18, v142, v138, 16
    v_alignbit_b32 v22, v146, v142, 16
    v_alignbit_b32 v19, v143, v139, 16
    v_alignbit_b32 v23, v147, v143, 16
    ds_write_b128 v165, v[136:139] offset:2080
    ds_write_b128 v165, v[16:19] offset:6240
    ds_write_b128 v165, v[140:143] offset:10400
    ds_write_b128 v165, v[20:23] offset:14560
    v_alignbit_b32 v24, v152, v148, 16
    v_alignbit_b32 v28, v156, v152, 16
    v_alignbit_b32 v25, v153, v149, 16
    v_alignbit_b32 v29, v157, v153, 16
    v_alignbit_b32 v26, v154, v150, 16
    v_alignbit_b32 v30, v158, v154, 16
    v_alignbit_b32 v27, v155, v151, 16
    v_alignbit_b32 v31, v159, v155, 16
    ds_write_b128 v165, v[148:151] offset:3104
    ds_write_b128 v165, v[24:27] offset:7264
    ds_write_b128 v165, v[152:155] offset:11424
    ds_write_b128 v165, v[28:31] offset:15584
    v_mov_b32 v32, 0
    v_mov_b32 v33, 0
    v_mov_b32 v34, 0
    v_mov_b32 v35, 0
    v_alignbit_b32 v36, v116, v112, 16
    v_lshlrev_b32 v37, 16, v112
    v_mov_b32 v38, v112
    v_lshrrev_b32 v2, 1, v1
    v_mul_u32_u24 v2, 4160, v2
    v_and_b32 v3, 1, v1
    v_lshlrev_b32 v3, 4, v3
    v_add_u32 v2, v2, v3
    v_add_u32 v2, s85, v2
    s_mov_b64 exec, 0xff
    ds_write_b128 v2, v[32:35]
    s_mov_b64 exec, 0xffffffff
    ds_write_b128 v165, v[32:35] offset:20736
    s_mov_b64 exec, 1
    ds_write_b32 v165, v37 offset:4188
    ds_write_b32 v165, v38 offset:8348
    ds_write_b32 v165, v37 offset:12504
    ds_write_b32 v165, v36 offset:12508
    s_mov_b64 exec, -1
    s_waitcnt lgkmcnt(0)
    v_mov_b32 v48, v165
    v_mov_b32 v49, v164
    v_mov_b32 v2, 162388
    s_mov_b32 s43, 0
lw_184:
    ds_read_b32 v3, v2
    s_waitcnt lgkmcnt(0)
    v_readfirstlane_b32 s42, v3
    s_nop 3
    s_cmp_ge_u32 s42, 1
    s_cbranch_scc1 lwd_185
    s_add_u32 s43, s43, 1
    s_cmp_lt_u32 s43, 320000
    s_cbranch_scc0 lwd_185
    s_sleep 2
    s_branch lw_184
lwd_185:
    s_lshl_b32 s28, s83, 12
    s_add_u32 s28, s28, 262144
    s_add_u32 s29, s28, 0
    buffer_load_dwordx4 v[80:83], v49, s[12:15], s29 offen sc1
    s_add_u32 s29, s28, 1024
    buffer_load_dwordx4 v[84:87], v49, s[12:15], s29 offen sc1
    s_add_u32 s29, s28, 2048
    buffer_load_dwordx4 v[88:91], v49, s[12:15], s29 offen sc1
    s_add_u32 s29, s28, 3072
    buffer_load_dwordx4 v[92:95], v49, s[12:15], s29 offen sc1
    v_and_b32 v2, 15, v1
    v_lshrrev_b32 v3, 4, v1
    v_add_u32 v162, 1, v2
    v_and_b32 v163, 3, v162
    v_mul_u32_u24 v160, 4160, v163
    v_lshrrev_b32 v162, 2, v162
    v_lshlrev_b32 v162, 3, v162
    v_lshlrev_b32 v163, 4, v3
    v_add_u32 v160, v160, v162
    v_add_u32 v160, v160, v163
    v_add_u32 v160, s85, v160
    v_lshlrev_b32 v162, 5, v2
    v_sub_u32 v161, v163, v162
    s_add_u32 s28, s85, 17120
    v_add_u32 v161, s28, v161
    s_and_b32 s30, s83, 1
    s_lshl_b32 s30, s30, 4
    s_lshr_b32 s88, s88, s30
    s_and_b32 s88, s88, 0xffff
    v_lshlrev_b32 v3, 3, v3
    v_add_u32 v2, v2, v3
    v_sub_u32 v2, 15, v2
    v_and_b32 v3, 1, v2
    v_lshlrev_b32 v3, 4, v3
    v_mov_b32 v162, s88
    v_lshlrev_b32 v162, v3, v162
    v_lshrrev_b32 v2, 1, v2
    v_cmp_eq_u32 vcc, 0, v2
    s_nop 1
    v_cndmask_b32 v112, 0, v162, vcc
    v_cmp_eq_u32 vcc, 1, v2
    s_nop 1
    v_cndmask_b32 v113, 0, v162, vcc
    v_cmp_eq_u32 vcc, 2, v2
    s_nop 1
    v_cndmask_b32 v114, 0, v162, vcc
    v_cmp_eq_u32 vcc, 3, v2
    s_nop 1
    v_cndmask_b32 v115, 0, v162, vcc
    v_mov_b32 v16, 0
    v_mov_b32 v17, 0
    v_mov_b32 v18, 0
    v_mov_b32 v19, 0
    v_mov_b32 v20, 0
    v_mov_b32 v21, 0
    v_mov_b32 v22, 0
    v_mov_b32 v23, 0
    v_mov_b32 v24, 0
    v_mov_b32 v25, 0
    v_mov_b32 v26, 0
    v_mov_b32 v27, 0
    v_mov_b32 v28, 0
    v_mov_b32 v29, 0
    v_mov_b32 v30, 0
    v_mov_b32 v31, 0
    v_mov_b32 v32, 0
    v_mov_b32 v33, 0
    v_mov_b32 v34, 0
    v_mov_b32 v35, 0
    v_mov_b32 v36, 0
    v_mov_b32 v37, 0
    v_mov_b32 v38, 0
    v_mov_b32 v39, 0
    v_mov_b32 v40, 0
    v_mov_b32 v41, 0
    v_mov_b32 v42, 0
    v_mov_b32 v43, 0
    v_mov_b32 v44, 0
    v_mov_b32 v45, 0
    v_mov_b32 v46, 0
    v_mov_b32 v47, 0
    s_waitcnt vmcnt(0)
    ds_write_b128 v48, v[80:83] offset:16640
    ds_write_b128 v48, v[84:87] offset:17664
    ds_write_b128 v48, v[88:91] offset:18688
    ds_write_b128 v48, v[92:95] offset:19712
    s_waitcnt lgkmcnt(0)
    s_setprio 0
    s_mov_b32 s86, 0
convph_186:
    ds_read_b64 v[48:49], v160
    ds_read_b64 v[50:51], v160 offset:8
    ds_read_b128 v[80:83], v161 offset:3584
    ds_read_b128 v[84:87], v161 offset:3072
    ds_read_b128 v[88:91], v161 offset:2560
    ds_read_b128 v[92:95], v161 offset:2048
    ds_read_b128 v[96:99], v161 offset:1536
    ds_read_b128 v[100:103], v161 offset:1024
    ds_read_b128 v[104:107], v161 offset:512
    ds_read_b128 v[108:111], v161 offset:0
    ds_read_b64 v[52:53], v160 offset:512
    ds_read_b64 v[54:55], v160 offset:520
    ds_read_b64 v[56:57], v160 offset:1024
    ds_read_b64 v[58:59], v160 offset:1032
    s_waitcnt lgkmcnt(4)
    ds_read_b64 v[60:61], v160 offset:1536
    ds_read_b64 v[62:63], v160 offset:1544
    ds_read_b64 v[64:65], v160 offset:2048
    ds_read_b64 v[66:67], v160 offset:2056
    ds_read_b64 v[68:69], v160 offset:2560
    ds_read_b64 v[70:71], v160 offset:2568
    ds_read_b64 v[72:73], v160 offset:3072
    ds_read_b64 v[74:75], v160 offset:3080
    ds_read_b64 v[76:77], v160 offset:3584
    ds_read_b64 v[78:79], v160 offset:3592
    v_mfma_f32_16x16x32_bf16 v[16:19], v[48:51], v[80:83], v[16:19]
    v_mfma_f32_16x16x32_bf16 v[20:23], v[48:51], v[84:87], v[20:23]
    v_mfma_f32_16x16x32_bf16 v[24:27], v[48:51], v[88:91], v[24:27]
    v_mfma_f32_16x16x32_bf16 v[28:31], v[48:51], v[92:95], v[28:31]
    v_mfma_f32_16x16x32_bf16 v[32:35], v[48:51], v[96:99], v[32:35]
    v_mfma_f32_16x16x32_bf16 v[36:39], v[48:51], v[100:103], v[36:39]
    v_mfma_f32_16x16x32_bf16 v[40:43], v[48:51], v[104:107], v[40:43]
    v_mfma_f32_16x16x32_bf16 v[44:47], v[48:51], v[108:111], v[44:47]
    s_cmp_lg_u32 s86, 0
    s_cbranch_scc1 noD_187
    v_mfma_f32_16x16x32_bf16 v[16:19], v[112:115], v[80:83], v[16:19]
    v_mfma_f32_16x16x32_bf16 v[20:23], v[112:115], v[84:87], v[20:23]
    v_mfma_f32_16x16x32_bf16 v[24:27], v[112:115], v[88:91], v[24:27]
    v_mfma_f32_16x16x32_bf16 v[28:31], v[112:115], v[92:95], v[28:31]
    v_mfma_f32_16x16x32_bf16 v[32:35], v[112:115], v[96:99], v[32:35]
    v_mfma_f32_16x16x32_bf16 v[36:39], v[112:115], v[100:103], v[36:39]
    v_mfma_f32_16x16x32_bf16 v[40:43], v[112:115], v[104:107], v[40:43]
    v_mfma_f32_16x16x32_bf16 v[44:47], v[112:115], v[108:111], v[44:47]
noD_187:
    s_waitcnt lgkmcnt(0)
    v_mfma_f32_16x16x32_bf16 v[20:23], v[52:55], v[80:83], v[20:23]
    v_mfma_f32_16x16x32_bf16 v[24:27], v[52:55], v[84:87], v[24:27]
    v_mfma_f32_16x16x32_bf16 v[28:31], v[52:55], v[88:91], v[28:31]
    v_mfma_f32_16x16x32_bf16 v[32:35], v[52:55], v[92:95], v[32:35]
    v_mfma_f32_16x16x32_bf16 v[36:39], v[52:55], v[96:99], v[36:39]
    v_mfma_f32_16x16x32_bf16 v[40:43], v[52:55], v[100:103], v[40:43]
    v_mfma_f32_16x16x32_bf16 v[44:47], v[52:55], v[104:107], v[44:47]
    v_mfma_f32_16x16x32_bf16 v[24:27], v[56:59], v[80:83], v[24:27]
    v_mfma_f32_16x16x32_bf16 v[28:31], v[56:59], v[84:87], v[28:31]
    v_mfma_f32_16x16x32_bf16 v[32:35], v[56:59], v[88:91], v[32:35]
    v_mfma_f32_16x16x32_bf16 v[36:39], v[56:59], v[92:95], v[36:39]
    v_mfma_f32_16x16x32_bf16 v[40:43], v[56:59], v[96:99], v[40:43]
    v_mfma_f32_16x16x32_bf16 v[44:47], v[56:59], v[100:103], v[44:47]
    v_mfma_f32_16x16x32_bf16 v[28:31], v[60:63], v[80:83], v[28:31]
    v_mfma_f32_16x16x32_bf16 v[32:35], v[60:63], v[84:87], v[32:35]
    v_mfma_f32_16x16x32_bf16 v[36:39], v[60:63], v[88:91], v[36:39]
    v_mfma_f32_16x16x32_bf16 v[40:43], v[60:63], v[92:95], v[40:43]
    v_mfma_f32_16x16x32_bf16 v[44:47], v[60:63], v[96:99], v[44:47]
    v_mfma_f32_16x16x32_bf16 v[32:35], v[64:67], v[80:83], v[32:35]
    v_mfma_f32_16x16x32_bf16 v[36:39], v[64:67], v[84:87], v[36:39]
    v_mfma_f32_16x16x32_bf16 v[40:43], v[64:67], v[88:91], v[40:43]
    v_mfma_f32_16x16x32_bf16 v[44:47], v[64:67], v[92:95], v[44:47]
    v_mfma_f32_16x16x32_bf16 v[36:39], v[68:71], v[80:83], v[36:39]
    v_mfma_f32_16x16x32_bf16 v[40:43], v[68:71], v[84:87], v[40:43]
    v_mfma_f32_16x16x32_bf16 v[44:47], v[68:71], v[88:91], v[44:47]
    v_mfma_f32_16x16x32_bf16 v[40:43], v[72:75], v[80:83], v[40:43]
    v_mfma_f32_16x16x32_bf16 v[44:47], v[72:75], v[84:87], v[44:47]
    v_mfma_f32_16x16x32_bf16 v[44:47], v[76:79], v[80:83], v[44:47]
    v_add_u32 v160, 64, v160
    v_add_u32 v161, 64, v161
    s_add_u32 s86, s86, 1
    s_cmp_lt_u32 s86, 8
    s_cbranch_scc1 convph_186
    s_lshl_b32 s28, s83, 12
    s_add_u32 s28, s28, 2883584
    v_and_b32 v162, 15, v1
    v_lshlrev_b32 v162, 5, v162
    v_lshrrev_b32 v163, 4, v1
    v_lshlrev_b32 v163, 3, v163
    v_add_u32 v162, v162, v163
    s_nop 3
    v_cvt_pk_bf16_f32 v80, v16, v17
    v_cvt_pk_bf16_f32 v81, v18, v19
    buffer_store_dwordx2 v[80:81], v162, s[12:15], s28 offen offset:0 sc1
    v_cvt_pk_bf16_f32 v82, v20, v21
    v_cvt_pk_bf16_f32 v83, v22, v23
    buffer_store_dwordx2 v[82:83], v162, s[12:15], s28 offen offset:512 sc1
    v_cvt_pk_bf16_f32 v84, v24, v25
    v_cvt_pk_bf16_f32 v85, v26, v27
    buffer_store_dwordx2 v[84:85], v162, s[12:15], s28 offen offset:1024 sc1
    v_cvt_pk_bf16_f32 v86, v28, v29
    v_cvt_pk_bf16_f32 v87, v30, v31
    buffer_store_dwordx2 v[86:87], v162, s[12:15], s28 offen offset:1536 sc1
    v_cvt_pk_bf16_f32 v88, v32, v33
    v_cvt_pk_bf16_f32 v89, v34, v35
    buffer_store_dwordx2 v[88:89], v162, s[12:15], s28 offen offset:2048 sc1
    v_cvt_pk_bf16_f32 v90, v36, v37
    v_cvt_pk_bf16_f32 v91, v38, v39
    buffer_store_dwordx2 v[90:91], v162, s[12:15], s28 offen offset:2560 sc1
    v_cvt_pk_bf16_f32 v92, v40, v41
    v_cvt_pk_bf16_f32 v93, v42, v43
    buffer_store_dwordx2 v[92:93], v162, s[12:15], s28 offen offset:3072 sc1
    v_cvt_pk_bf16_f32 v94, v44, v45
    v_cvt_pk_bf16_f32 v95, v46, v47
    buffer_store_dwordx2 v[94:95], v162, s[12:15], s28 offen offset:3584 sc1
    s_waitcnt vmcnt(0)
noconv_181:
    s_setprio 3
    v_mov_b32 v2, 162384
    v_mov_b32 v3, 1
    s_mov_b64 exec, 1
    ds_add_u32 v2, v3
    s_mov_b64 exec, -1
    v_lshlrev_b32 v121, 4, v1
    s_mul_i32 s29, s21, 160
    v_add_u32 v2, 0, v1
    v_mul_u32_u24 v3, 6554, v2
    v_lshrrev_b32 v3, 16, v3
    v_mul_u32_u24 v164, 10, v3
    v_sub_u32 v2, v2, v164
    v_lshlrev_b32 v2, 4, v2
    v_and_b32 v164, 0xfff3, v3
    v_bfe_u32 v165, v3, 2, 1
    v_lshlrev_b32 v165, 3, v165
    v_or_b32 v164, v164, v165
    v_bfe_u32 v165, v3, 3, 1
    v_lshlrev_b32 v165, 2, v165
    v_or_b32 v164, v164, v165
    v_mul_lo_u32 v164, v164, s26
    v_add_u32 v164, v164, v2
    v_add_u32 v116, s29, v164
    v_add_u32 v2, 64, v1
    v_mul_u32_u24 v3, 6554, v2
    v_lshrrev_b32 v3, 16, v3
    v_mul_u32_u24 v164, 10, v3
    v_sub_u32 v2, v2, v164
    v_lshlrev_b32 v2, 4, v2
    v_and_b32 v164, 0xfff3, v3
    v_bfe_u32 v165, v3, 2, 1
    v_lshlrev_b32 v165, 3, v165
    v_or_b32 v164, v164, v165
    v_bfe_u32 v165, v3, 3, 1
    v_lshlrev_b32 v165, 2, v165
    v_or_b32 v164, v164, v165
    v_mul_lo_u32 v164, v164, s26
    v_add_u32 v164, v164, v2
    v_add_u32 v117, s29, v164
    v_add_u32 v2, 128, v1
    v_mul_u32_u24 v3, 6554, v2
    v_lshrrev_b32 v3, 16, v3
    v_mul_u32_u24 v164, 10, v3
    v_sub_u32 v2, v2, v164
    v_lshlrev_b32 v2, 4, v2
    v_and_b32 v164, 0xfff3, v3
    v_bfe_u32 v165, v3, 2, 1
    v_lshlrev_b32 v165, 3, v165
    v_or_b32 v164, v164, v165
    v_bfe_u32 v165, v3, 3, 1
    v_lshlrev_b32 v165, 2, v165
    v_or_b32 v164, v164, v165
    v_mul_lo_u32 v164, v164, s26
    v_add_u32 v164, v164, v2
    v_add_u32 v118, s29, v164
    v_add_u32 v2, 192, v1
    v_mul_u32_u24 v3, 6554, v2
    v_lshrrev_b32 v3, 16, v3
    v_mul_u32_u24 v164, 10, v3
    v_sub_u32 v2, v2, v164
    v_lshlrev_b32 v2, 4, v2
    v_and_b32 v164, 0xfff3, v3
    v_bfe_u32 v165, v3, 2, 1
    v_lshlrev_b32 v165, 3, v165
    v_or_b32 v164, v164, v165
    v_bfe_u32 v165, v3, 3, 1
    v_lshlrev_b32 v165, 2, v165
    v_or_b32 v164, v164, v165
    v_mul_lo_u32 v164, v164, s26
    v_add_u32 v164, v164, v2
    v_add_u32 v119, s29, v164
    v_add_u32 v2, 256, v1
    v_mul_u32_u24 v3, 6554, v2
    v_lshrrev_b32 v3, 16, v3
    v_mul_u32_u24 v164, 10, v3
    v_sub_u32 v2, v2, v164
    v_lshlrev_b32 v2, 4, v2
    v_and_b32 v164, 0xfff3, v3
    v_bfe_u32 v165, v3, 2, 1
    v_lshlrev_b32 v165, 3, v165
    v_or_b32 v164, v164, v165
    v_bfe_u32 v165, v3, 3, 1
    v_lshlrev_b32 v165, 2, v165
    v_or_b32 v164, v164, v165
    v_mul_lo_u32 v164, v164, s26
    v_add_u32 v164, v164, v2
    v_add_u32 v120, s29, v164
    v_mov_b32 v2, 162424
    s_mov_b32 s43, 0
lw_188:
    ds_read_b32 v3, v2
    s_waitcnt lgkmcnt(0)
    v_readfirstlane_b32 s42, v3
    s_nop 3
    s_cmp_ge_u32 s42, 8
    s_cbranch_scc1 lwd_189
    s_add_u32 s43, s43, 1
    s_cmp_lt_u32 s43, 320000
    s_cbranch_scc0 lwd_189
    s_sleep 2
    s_branch lw_188
lwd_189:
    s_cmp_lg_u32 s34, 0
    s_cbranch_scc1 ifw_190
    s_mov_b32 s30, 0
    s_mov_b32 m0, 56576
    s_nop 0
    buffer_load_dwordx4 v116, s[64:67], s30 offen lds
    s_mov_b32 m0, 57600
    s_nop 0
    buffer_load_dwordx4 v117, s[64:67], s30 offen lds
    s_mov_b32 m0, 58624
    s_nop 0
    buffer_load_dwordx4 v118, s[64:67], s30 offen lds
    s_mov_b32 m0, 59648
    s_nop 0
    buffer_load_dwordx4 v119, s[64:67], s30 offen lds
    s_mov_b32 m0, 60672
    s_nop 0
    buffer_load_dwordx4 v120, s[64:67], s30 offen lds
    s_mov_b32 s30, 40960
    s_mov_b32 m0, 61696
    s_nop 0
    buffer_load_dwordx4 v116, s[64:67], s30 offen lds
    s_mov_b32 m0, 62720
    s_nop 0
    buffer_load_dwordx4 v117, s[64:67], s30 offen lds
    s_mov_b32 m0, 63744
    s_nop 0
    buffer_load_dwordx4 v118, s[64:67], s30 offen lds
    s_mov_b32 m0, 64768
    s_nop 0
    buffer_load_dwordx4 v119, s[64:67], s30 offen lds
    s_mov_b32 m0, 65792
    s_nop 0
    buffer_load_dwordx4 v120, s[64:67], s30 offen lds
ifw_190:
    s_cmp_lg_u32 s34, 1
    s_cbranch_scc1 ifw_191
    s_mov_b32 s30, 122880
    s_mov_b32 m0, 71936
    s_nop 0
    buffer_load_dwordx4 v116, s[64:67], s30 offen lds
    s_mov_b32 m0, 72960
    s_nop 0
    buffer_load_dwordx4 v117, s[64:67], s30 offen lds
    s_mov_b32 m0, 73984
    s_nop 0
    buffer_load_dwordx4 v118, s[64:67], s30 offen lds
    s_mov_b32 m0, 75008
    s_nop 0
    buffer_load_dwordx4 v119, s[64:67], s30 offen lds
    s_mov_b32 m0, 76032
    s_nop 0
    buffer_load_dwordx4 v120, s[64:67], s30 offen lds
    s_mov_b32 s30, 163840
    s_mov_b32 m0, 77056
    s_nop 0
    buffer_load_dwordx4 v116, s[64:67], s30 offen lds
    s_mov_b32 m0, 78080
    s_nop 0
    buffer_load_dwordx4 v117, s[64:67], s30 offen lds
    s_mov_b32 m0, 79104
    s_nop 0
    buffer_load_dwordx4 v118, s[64:67], s30 offen lds
    s_mov_b32 m0, 80128
    s_nop 0
    buffer_load_dwordx4 v119, s[64:67], s30 offen lds
    s_mov_b32 m0, 81152
    s_nop 0
    buffer_load_dwordx4 v120, s[64:67], s30 offen lds
    s_mov_b32 s30, 204800
    s_mov_b32 m0, 82176
    s_nop 0
    buffer_load_dwordx4 v116, s[64:67], s30 offen lds
    s_mov_b32 m0, 83200
    s_nop 0
    buffer_load_dwordx4 v117, s[64:67], s30 offen lds
    s_mov_b32 m0, 84224
    s_nop 0
    buffer_load_dwordx4 v118, s[64:67], s30 offen lds
    s_mov_b32 m0, 85248
    s_nop 0
    buffer_load_dwordx4 v119, s[64:67], s30 offen lds
    s_mov_b32 m0, 86272
    s_nop 0
    buffer_load_dwordx4 v120, s[64:67], s30 offen lds
ifw_191:
    s_cmp_lg_u32 s34, 2
    s_cbranch_scc1 ifw_192
    s_mov_b32 s30, 286720
    s_mov_b32 m0, 92416
    s_nop 0
    buffer_load_dwordx4 v116, s[64:67], s30 offen lds
    s_mov_b32 m0, 93440
    s_nop 0
    buffer_load_dwordx4 v117, s[64:67], s30 offen lds
    s_mov_b32 m0, 94464
    s_nop 0
    buffer_load_dwordx4 v118, s[64:67], s30 offen lds
    s_mov_b32 m0, 95488
    s_nop 0
    buffer_load_dwordx4 v119, s[64:67], s30 offen lds
    s_mov_b32 m0, 96512
    s_nop 0
    buffer_load_dwordx4 v120, s[64:67], s30 offen lds
    s_mov_b32 s30, 327680
    s_mov_b32 m0, 97536
    s_nop 0
    buffer_load_dwordx4 v116, s[64:67], s30 offen lds
    s_mov_b32 m0, 98560
    s_nop 0
    buffer_load_dwordx4 v117, s[64:67], s30 offen lds
    s_mov_b32 m0, 99584
    s_nop 0
    buffer_load_dwordx4 v118, s[64:67], s30 offen lds
    s_mov_b32 m0, 100608
    s_nop 0
    buffer_load_dwordx4 v119, s[64:67], s30 offen lds
    s_mov_b32 m0, 101632
    s_nop 0
    buffer_load_dwordx4 v120, s[64:67], s30 offen lds
    s_mov_b32 s30, 368640
    s_mov_b32 m0, 102656
    s_nop 0
    buffer_load_dwordx4 v116, s[64:67], s30 offen lds
    s_mov_b32 m0, 103680
    s_nop 0
    buffer_load_dwordx4 v117, s[64:67], s30 offen lds
    s_mov_b32 m0, 104704
    s_nop 0
    buffer_load_dwordx4 v118, s[64:67], s30 offen lds
    s_mov_b32 m0, 105728
    s_nop 0
    buffer_load_dwordx4 v119, s[64:67], s30 offen lds
    s_mov_b32 m0, 106752
    s_nop 0
    buffer_load_dwordx4 v120, s[64:67], s30 offen lds
    s_mov_b32 s30, 409600
    s_mov_b32 m0, 107776
    s_nop 0
    buffer_load_dwordx4 v116, s[64:67], s30 offen lds
    s_mov_b32 m0, 108800
    s_nop 0
    buffer_load_dwordx4 v117, s[64:67], s30 offen lds
    s_mov_b32 m0, 109824
    s_nop 0
    buffer_load_dwordx4 v118, s[64:67], s30 offen lds
    s_mov_b32 m0, 110848
    s_nop 0
    buffer_load_dwordx4 v119, s[64:67], s30 offen lds
    s_mov_b32 m0, 111872
    s_nop 0
    buffer_load_dwordx4 v120, s[64:67], s30 offen lds
ifw_192:
    v_mov_b32 v2, 162384
    s_mov_b32 s43, 0
lw_193:
    ds_read_b32 v3, v2
    s_waitcnt lgkmcnt(0)
    v_readfirstlane_b32 s42, v3
    s_nop 3
    s_cmp_ge_u32 s42, 3
    s_cbranch_scc1 lwd_194
    s_add_u32 s43, s43, 1
    s_cmp_lt_u32 s43, 320000
    s_cbranch_scc0 lwd_194
    s_sleep 4
    s_branch lw_193
lwd_194:
    s_cmp_lg_u32 s34, 2
    s_cbranch_scc1 ifw_195
    s_add_u32 s29, s90, 8175616
    v_lshlrev_b32 v2, 10, v1
    v_mov_b32 v3, s25
    s_mov_b64 exec, 0xffffffff
    buffer_store_dword v3, v2, s[12:15], s29 offen sc1
    s_mov_b64 exec, -1
ifw_195:
    s_cmp_lg_u32 s34, 0
    s_cbranch_scc1 ifw_196
    s_mov_b32 s30, 81920
    s_mov_b32 m0, 66816
    s_nop 0
    buffer_load_dwordx4 v116, s[64:67], s30 offen lds
    s_mov_b32 m0, 67840
    s_nop 0
    buffer_load_dwordx4 v117, s[64:67], s30 offen lds
    s_mov_b32 m0, 68864
    s_nop 0
    buffer_load_dwordx4 v118, s[64:67], s30 offen lds
    s_mov_b32 m0, 69888
    s_nop 0
    buffer_load_dwordx4 v119, s[64:67], s30 offen lds
    s_mov_b32 m0, 70912
    s_nop 0
    buffer_load_dwordx4 v120, s[64:67], s30 offen lds
ifw_196:
    s_cmp_lg_u32 s34, 1
    s_cbranch_scc1 ifw_197
    s_mov_b32 s30, 245760
    s_mov_b32 m0, 87296
    s_nop 0
    buffer_load_dwordx4 v116, s[64:67], s30 offen lds
    s_mov_b32 m0, 88320
    s_nop 0
    buffer_load_dwordx4 v117, s[64:67], s30 offen lds
    s_mov_b32 m0, 89344
    s_nop 0
    buffer_load_dwordx4 v118, s[64:67], s30 offen lds
    s_mov_b32 m0, 90368
    s_nop 0
    buffer_load_dwordx4 v119, s[64:67], s30 offen lds
    s_mov_b32 m0, 91392
    s_nop 0
    buffer_load_dwordx4 v120, s[64:67], s30 offen lds
ifw_197:
    s_waitcnt vmcnt(0)
    v_mov_b32 v2, 162428
    v_mov_b32 v3, 1
    s_mov_b64 exec, 1
    ds_add_u32 v2, v3
    s_mov_b64 exec, -1
    s_cmp_lg_u32 s34, 2
    s_cbranch_scc1 ifw_198
    v_lshlrev_b32 v98, 2, v1
    s_add_u32 s29, s89, 8175616
    s_mov_b32 s40, 4294967295
    s_mov_b32 s41, 0
    s_mov_b32 s43, 0
poll_199:
    buffer_load_dword v99, v98, s[12:15], s29 offen sc1
    s_waitcnt vmcnt(0)
    v_cmp_ne_u32 vcc, s25, v99
    s_nop 1
    s_and_b64 vcc, vcc, s[40:41]
    s_cmp_eq_u64 vcc, 0
    s_cbranch_scc1 pdone_200
    s_add_u32 s43, s43, 1
    s_cmp_lt_u32 s43, 40000
    s_cbranch_scc0 pdone_200
    s_sleep 2
    s_branch poll_199
pdone_200:
    v_mov_b32 v2, 162392
    v_mov_b32 v3, 1
    ds_write_b32 v2, v3
ifw_198:
    s_cmp_lg_u32 s34, 0
    s_cbranch_scc1 ifw_201
    v_lshrrev_b32 v164, 3, v1
    v_lshlrev_b32 v164, 12, v164
    v_and_b32 v165, 7, v1
    v_lshlrev_b32 v165, 4, v165
    v_add_u32 v164, v164, v165
    v_mov_b32 v2, 162392
    s_mov_b32 s43, 0
lw_202:
    ds_read_b32 v3, v2
    s_waitcnt lgkmcnt(0)
    v_readfirstlane_b32 s42, v3
    s_nop 3
    s_cmp_ge_u32 s42, 1
    s_cbranch_scc1 lwd_203
    s_add_u32 s43, s43, 1
    s_cmp_lt_u32 s43, 320000
    s_cbranch_scc0 lwd_203
    s_sleep 2
    s_branch lw_202
lwd_203:
    s_mul_i32 s28, s21, 327680
    s_lshl_b32 s29, s20, 7
    s_add_u32 s28, s28, s29
    s_add_u32 s28, s28, 2883584
    buffer_load_dwordx4 v[32:35], v164, s[12:15], s28 offen sc1
    s_add_u32 s28, s28, 32768
    buffer_load_dwordx4 v[36:39], v164, s[12:15], s28 offen sc1
    s_add_u32 s28, s28, 32768
    buffer_load_dwordx4 v[40:43], v164, s[12:15], s28 offen sc1
    s_add_u32 s28, s28, 32768
    buffer_load_dwordx4 v[44:47], v164, s[12:15], s28 offen sc1
    s_add_u32 s28, s28, 32768
    buffer_load_dwordx4 v[48:51], v164, s[12:15], s28 offen sc1
    s_add_u32 s28, s28, 32768
    v_add_u32 v164, 36864, v121
    v_mov_b32 v2, 162544
    s_mov_b32 s43, 0
lw_204:
    ds_read_b32 v3, v2
    s_waitcnt lgkmcnt(0)
    v_readfirstlane_b32 s42, v3
    s_nop 3
    s_cmp_ge_u32 s42, 8
    s_cbranch_scc1 lwd_205
    s_add_u32 s43, s43, 1
    s_cmp_lt_u32 s43, 320000
    s_cbranch_scc0 lwd_205
    s_sleep 1
    s_branch lw_204
lwd_205:
    s_waitcnt vmcnt(0)
    ds_write_b128 v164, v[32:35] offset:0
    ds_write_b128 v164, v[36:39] offset:1024
    ds_write_b128 v164, v[40:43] offset:2048
    ds_write_b128 v164, v[44:47] offset:3072
    ds_write_b128 v164, v[48:51] offset:4096
    v_mov_b32 v2, 162528
    v_mov_b32 v3, 1
    s_mov_b64 exec, 1
    ds_add_u32 v2, v3
    s_mov_b64 exec, -1
ifw_201:
    s_cmp_lg_u32 s34, 1
    s_cbranch_scc1 ifw_206
    v_lshrrev_b32 v164, 3, v1
    v_lshlrev_b32 v164, 12, v164
    v_and_b32 v165, 7, v1
    v_lshlrev_b32 v165, 4, v165
    v_add_u32 v164, v164, v165
    v_mov_b32 v2, 162392
    s_mov_b32 s43, 0
lw_207:
    ds_read_b32 v3, v2
    s_waitcnt lgkmcnt(0)
    v_readfirstlane_b32 s42, v3
    s_nop 3
    s_cmp_ge_u32 s42, 1
    s_cbranch_scc1 lwd_208
    s_add_u32 s43, s43, 1
    s_cmp_lt_u32 s43, 320000
    s_cbranch_scc0 lwd_208
    s_sleep 2
    s_branch lw_207
lwd_208:
    s_mul_i32 s28, s21, 327680
    s_lshl_b32 s29, s20, 7
    s_add_u32 s28, s28, s29
    s_add_u32 s28, s28, 3047424
    buffer_load_dwordx4 v[32:35], v164, s[12:15], s28 offen sc1
    s_add_u32 s28, s28, 32768
    buffer_load_dwordx4 v[36:39], v164, s[12:15], s28 offen sc1
    s_add_u32 s28, s28, 32768
    buffer_load_dwordx4 v[40:43], v164, s[12:15], s28 offen sc1
    s_add_u32 s28, s28, 32768
    buffer_load_dwordx4 v[44:47], v164, s[12:15], s28 offen sc1
    s_add_u32 s28, s28, 32768
    buffer_load_dwordx4 v[48:51], v164, s[12:15], s28 offen sc1
    s_add_u32 s28, s28, 32768
    v_add_u32 v164, 41984, v121
    v_mov_b32 v2, 162544
    s_mov_b32 s43, 0
lw_209:
    ds_read_b32 v3, v2
    s_waitcnt lgkmcnt(0)
    v_readfirstlane_b32 s42, v3
    s_nop 3
    s_cmp_ge_u32 s42, 8
    s_cbranch_scc1 lwd_210
    s_add_u32 s43, s43, 1
    s_cmp_lt_u32 s43, 320000
    s_cbranch_scc0 lwd_210
    s_sleep 1
    s_branch lw_209
lwd_210:
    s_waitcnt vmcnt(0)
    ds_write_b128 v164, v[32:35] offset:0
    ds_write_b128 v164, v[36:39] offset:1024
    ds_write_b128 v164, v[40:43] offset:2048
    ds_write_b128 v164, v[44:47] offset:3072
    ds_write_b128 v164, v[48:51] offset:4096
    v_mov_b32 v2, 162528
    v_mov_b32 v3, 1
    s_mov_b64 exec, 1
    ds_add_u32 v2, v3
    s_mov_b64 exec, -1
ifw_206:
f_fin:
f_end:
    s_endpgm
.section .rodata,"a"
.p2align 6
.amdhsa_kernel gated_mix__ssm_conv_h3__grouped_kv_mqa__prompt_kernel
  .amdhsa_next_free_vgpr 168
  .amdhsa_next_free_sgpr 102
  .amdhsa_accum_offset 168
  .amdhsa_group_segment_fixed_size 0
  .amdhsa_kernarg_size 120
  .amdhsa_user_sgpr_count 2
  .amdhsa_user_sgpr_kernarg_segment_ptr 1
  .amdhsa_system_sgpr_workgroup_id_x 1
  .amdhsa_float_denorm_mode_32 3
  .amdhsa_float_denorm_mode_16_64 3
.end_amdhsa_kernel
.text
```
